```python
import torch

def _softmax(x, axis=-1):
    return torch.softmax(x, dim=axis)
def _gelu(x):
    return torch.nn.functional.gelu(x, approximate="tanh")
def _silu(x):
    return torch.nn.functional.silu(x)
def _sigmoid(x):
    return torch.sigmoid(x)
def _layernorm(x, axis=-1, eps=1e-5):
    m = x.mean(dim=axis, keepdim=True)
    v = x.var(dim=axis, keepdim=True, unbiased=False)
    return (x - m) / torch.sqrt(v + eps)
def _scatter_add(tgt, idx, src, axis=0):
    return tgt.clone().index_add_(axis, idx, src)
def _segment_sum(src, seg, n):
    out = torch.zeros((n,) + src.shape[1:], dtype=src.dtype)
    return out.index_add_(0, seg, src)
def _pad(x, pw):
    flat = tuple(v for pair in reversed(pw) for v in pair)
    return torch.nn.functional.pad(x, flat)

kernel_name = 'standalone__gqa_softmax__near_ridge'

def setup_inputs():

    _w = (lambda a: (lambda t: t.to(torch.bfloat16) if t.is_floating_point() else t)(torch.as_tensor(a)))
    B, Hq, Hkv, Sq, Sk, D = 32, 16, 8, 256, 512, 256
    return {
        "q": _w((lambda *s: torch.randn(*s, dtype=torch.bfloat16) * 0.8)(B, Hq, Sq, D)),
        "k": _w((lambda *s: torch.randn(*s, dtype=torch.bfloat16) * 0.8)(B, Hkv, Sk, D)),
        "v": _w((lambda *s: torch.randn(*s, dtype=torch.bfloat16) * 0.05)(B, Hkv, Sk, D)),
    }

def reference(q, k, v):
    B, Hq, Sq, D = q.shape
    Hkv = k.shape[1]
    rep = Hq // Hkv
    k = (lambda x, n, axis: torch.repeat_interleave(x, n, dim=axis))(k, rep, axis=1)
    v = (lambda x, n, axis: torch.repeat_interleave(x, n, dim=axis))(v, rep, axis=1)
    scale = D ** -0.5
    scores = torch.einsum("bhqd,bhkd->bhqk", q, k) * scale
    p = _softmax(scores, axis=-1)
    return torch.einsum("bhqk,bhkd->bhqd", p, v)
```

```asm
; @launch grid=(256,1,1) block=(256,1,1) lds=163840
.amdgcn_target "amdgcn-amd-amdhsa--gfx950"
.text
.globl standalone__gqa_softmax__near_ridge_kernel
.p2align 8
.type standalone__gqa_softmax__near_ridge_kernel,@function
standalone__gqa_softmax__near_ridge_kernel:
    s_cmp_ge_u32 s2, 256
    s_cbranch_scc1 L_end
    s_load_dwordx4 s[4:7], s[0:1], 0
    s_load_dwordx4 s[36:39], s[0:1], 16
    s_and_b32 s42, s2, 7
    s_lshr_b32 s43, s2, 3
    s_and_b32 s44, s43, 1
    s_lshr_b32 s43, s43, 1
    s_lshl_b32 s42, s42, 4
    s_add_u32 s42, s42, s43
    s_lshl_b32 s45, s42, 1
    s_add_u32 s45, s45, s44
    v_lshrrev_b32 v33, 6, v0
    v_and_b32 v32, 63, v0
    s_nop 0
    v_readfirstlane_b32 s30, v33
    s_mov_b32 s28, 0x3db8aa3b
    s_nop 2
    s_lshl_b32 s26, s30, 12
    s_lshl_b32 s34, s30, 13
    s_add_u32 s34, s34, 0x20000
    s_lshl_b32 s24, s42, 18
    s_add_u32 s24, s24, s26
    s_mov_b32 s25, s24
    s_lshl_b32 s29, s45, 17
    s_lshl_b32 s43, s30, 15
    s_add_u32 s29, s29, s43
    s_add_u32 s31, s29, 0x2000000
    s_and_b32 s46, s30, 1
    s_lshl_b32 s46, s46, 7
    s_xor_b32 s47, s46, 0x80
    v_and_b32 v33, 31, v32
    v_lshrrev_b32 v34, 5, v32
    v_lshlrev_b32 v35, 9, v33
    v_and_b32 v36, 15, v33
    v_xor_b32 v36, v36, v34
    v_xor_b32 v37, 0, v36
    v_lshl_add_u32 v6, v37, 4, v35
    v_xor_b32 v37, 2, v36
    v_lshl_add_u32 v7, v37, 4, v35
    v_xor_b32 v37, 4, v36
    v_lshl_add_u32 v8, v37, 4, v35
    v_xor_b32 v37, 6, v36
    v_lshl_add_u32 v9, v37, 4, v35
    v_xor_b32 v37, 8, v36
    v_lshl_add_u32 v10, v37, 4, v35
    v_xor_b32 v37, 10, v36
    v_lshl_add_u32 v11, v37, 4, v35
    v_xor_b32 v37, 12, v36
    v_lshl_add_u32 v12, v37, 4, v35
    v_xor_b32 v37, 14, v36
    v_lshl_add_u32 v13, v37, 4, v35
    s_and_b32 s43, s30, 1
    s_lshl_b32 s43, s43, 3
    v_lshlrev_b32 v35, 9, v34
    v_xor_b32 v36, v33, v34
    v_xor_b32 v36, s43, v36
    v_xor_b32 v37, 0, v36
    v_lshl_add_u32 v0, v37, 4, v35
    v_xor_b32 v37, 2, v36
    v_lshl_add_u32 v1, v37, 4, v35
    v_xor_b32 v37, 4, v36
    v_lshl_add_u32 v2, v37, 4, v35
    v_xor_b32 v37, 6, v36
    v_lshl_add_u32 v3, v37, 4, v35
    v_lshlrev_b32 v36, 2, v34
    v_xor_b32 v36, v33, v36
    v_xor_b32 v37, 0, v36
    v_lshl_add_u32 v4, v37, 4, v35
    v_xor_b32 v37, 8, v36
    v_lshl_add_u32 v5, v37, 4, v35
    v_bfe_u32 v35, v32, 2, 2
    v_lshl_add_u32 v36, v34, 2, v35
    v_lshlrev_b32 v36, 9, v36
    v_add_u32 v36, 0x10000, v36
    v_bfe_u32 v37, v32, 4, 1
    v_lshl_add_u32 v36, v37, 5, v36
    v_and_b32 v37, 3, v32
    v_lshl_add_u32 v36, v37, 3, v36
    v_xor_b32 v37, 0, v35
    v_lshl_add_u32 v14, v37, 6, v36
    v_xor_b32 v37, 1, v35
    v_lshl_add_u32 v15, v37, 6, v36
    v_xor_b32 v37, 2, v35
    v_lshl_add_u32 v16, v37, 6, v36
    v_xor_b32 v37, 3, v35
    v_lshl_add_u32 v17, v37, 6, v36
    s_waitcnt lgkmcnt(0)
    s_mov_b32 s8, s4
    s_and_b32 s9, s5, 0xffff
    s_mov_b32 s10, 0x4000000
    s_mov_b32 s11, 0x20000
    s_mov_b32 s12, s6
    s_and_b32 s13, s7, 0xffff
    s_mov_b32 s14, 0x4000000
    s_mov_b32 s15, 0x20000
    s_mov_b32 s16, s36
    s_and_b32 s17, s37, 0xffff
    s_mov_b32 s18, 0x4000000
    s_mov_b32 s19, 0x20000
    s_mov_b32 s20, s38
    s_and_b32 s21, s39, 0xffff
    s_mov_b32 s22, 0x4000000
    s_mov_b32 s23, 0x20000
    s_mov_b32 s35, s46
    s_mov_b32 s36, s47
    s_mov_b32 s50, 0
    s_mov_b32 s51, 0
    s_mov_b32 s52, 0
    s_mov_b32 s53, 0
    s_mov_b32 s55, 0
    s_add_u32 s49, s26, 0x10000
    s_mov_b32 s58, 0x4000000
    s_mov_b32 s59, 0x20000
    s_mov_b32 s56, s12
    s_mov_b32 s57, s13
    s_lshr_b32 s43, s2, 4
    s_and_b32 s43, s43, 1
    s_add_u32 m0, s26, s50
    s_nop 0
    buffer_load_dwordx4 v0, s[12:15], s24 offen offset:0 nt lds
    s_nop 0
    buffer_load_dwordx4 v1, s[12:15], s24 offen offset:1024 nt lds
    s_nop 0
    buffer_load_dwordx4 v2, s[12:15], s24 offen offset:2048 nt lds
    s_nop 0
    buffer_load_dwordx4 v3, s[12:15], s24 offen offset:3072 nt lds
    s_nop 0
    s_add_u32 s24, s24, 0x4000
    s_add_u32 s50, s50, 0x4000
    s_and_b32 s50, s50, 0xffff
    s_nop 0
    s_add_u32 s37, s29, 0x0
    s_add_u32 m0, s34, 0x0
    s_nop 0
    v_xor_b32 v31, s35, v0
    buffer_load_dwordx4 v31, s[8:11], s37 offen offset:0 nt lds
    s_nop 0
    v_xor_b32 v31, s35, v1
    buffer_load_dwordx4 v31, s[8:11], s37 offen offset:1024 nt lds
    s_nop 0
    v_xor_b32 v31, s35, v2
    buffer_load_dwordx4 v31, s[8:11], s37 offen offset:2048 nt lds
    s_nop 0
    v_xor_b32 v31, s35, v3
    buffer_load_dwordx4 v31, s[8:11], s37 offen offset:3072 nt lds
    s_nop 0
    s_add_u32 s37, s29, 0x1000
    s_add_u32 m0, s34, 0x1000
    s_nop 0
    v_xor_b32 v31, s36, v0
    buffer_load_dwordx4 v31, s[8:11], s37 offen offset:0 nt lds
    s_nop 0
    v_xor_b32 v31, s36, v1
    buffer_load_dwordx4 v31, s[8:11], s37 offen offset:1024 nt lds
    s_nop 0
    v_xor_b32 v31, s36, v2
    buffer_load_dwordx4 v31, s[8:11], s37 offen offset:2048 nt lds
    s_nop 0
    v_xor_b32 v31, s36, v3
    buffer_load_dwordx4 v31, s[8:11], s37 offen offset:3072 nt lds
    s_nop 0
    s_add_u32 s37, s29, 0x2000
    s_add_u32 m0, s26, 0x8000
    s_nop 0
    v_xor_b32 v31, s35, v0
    buffer_load_dwordx4 v31, s[8:11], s37 offen offset:0 nt lds
    s_nop 0
    v_xor_b32 v31, s35, v1
    buffer_load_dwordx4 v31, s[8:11], s37 offen offset:1024 nt lds
    s_nop 0
    v_xor_b32 v31, s35, v2
    buffer_load_dwordx4 v31, s[8:11], s37 offen offset:2048 nt lds
    s_nop 0
    v_xor_b32 v31, s35, v3
    buffer_load_dwordx4 v31, s[8:11], s37 offen offset:3072 nt lds
    s_nop 0
    s_add_u32 s37, s29, 0x3000
    s_add_u32 m0, s26, 0xc000
    s_nop 0
    v_xor_b32 v31, s36, v0
    buffer_load_dwordx4 v31, s[8:11], s37 offen offset:0 nt lds
    s_nop 0
    v_xor_b32 v31, s36, v1
    buffer_load_dwordx4 v31, s[8:11], s37 offen offset:1024 nt lds
    s_nop 0
    v_xor_b32 v31, s36, v2
    buffer_load_dwordx4 v31, s[8:11], s37 offen offset:2048 nt lds
    s_nop 0
    v_xor_b32 v31, s36, v3
    buffer_load_dwordx4 v31, s[8:11], s37 offen offset:3072 nt lds
    s_nop 0
    s_add_u32 s37, s29, 0x4000
    s_add_u32 m0, s26, 0x10000
    s_nop 0
    v_xor_b32 v31, s35, v0
    buffer_load_dwordx4 v31, s[8:11], s37 offen offset:0 nt lds
    s_nop 0
    v_xor_b32 v31, s35, v1
    buffer_load_dwordx4 v31, s[8:11], s37 offen offset:1024 nt lds
    s_nop 0
    v_xor_b32 v31, s35, v2
    buffer_load_dwordx4 v31, s[8:11], s37 offen offset:2048 nt lds
    s_nop 0
    v_xor_b32 v31, s35, v3
    buffer_load_dwordx4 v31, s[8:11], s37 offen offset:3072 nt lds
    s_nop 0
    s_add_u32 s37, s29, 0x5000
    s_add_u32 m0, s26, 0x14000
    s_nop 0
    v_xor_b32 v31, s36, v0
    buffer_load_dwordx4 v31, s[8:11], s37 offen offset:0 nt lds
    s_nop 0
    v_xor_b32 v31, s36, v1
    buffer_load_dwordx4 v31, s[8:11], s37 offen offset:1024 nt lds
    s_nop 0
    v_xor_b32 v31, s36, v2
    buffer_load_dwordx4 v31, s[8:11], s37 offen offset:2048 nt lds
    s_nop 0
    v_xor_b32 v31, s36, v3
    buffer_load_dwordx4 v31, s[8:11], s37 offen offset:3072 nt lds
    s_nop 0
    s_add_u32 s37, s29, 0x6000
    s_add_u32 m0, s26, 0x18000
    s_nop 0
    v_xor_b32 v31, s35, v0
    buffer_load_dwordx4 v31, s[8:11], s37 offen offset:0 nt lds
    s_nop 0
    v_xor_b32 v31, s35, v1
    buffer_load_dwordx4 v31, s[8:11], s37 offen offset:1024 nt lds
    s_nop 0
    v_xor_b32 v31, s35, v2
    buffer_load_dwordx4 v31, s[8:11], s37 offen offset:2048 nt lds
    s_nop 0
    v_xor_b32 v31, s35, v3
    buffer_load_dwordx4 v31, s[8:11], s37 offen offset:3072 nt lds
    s_nop 0
    s_add_u32 s37, s29, 0x7000
    s_add_u32 m0, s26, 0x1c000
    s_nop 0
    v_xor_b32 v31, s36, v0
    buffer_load_dwordx4 v31, s[8:11], s37 offen offset:0 nt lds
    s_nop 0
    v_xor_b32 v31, s36, v1
    buffer_load_dwordx4 v31, s[8:11], s37 offen offset:1024 nt lds
    s_nop 0
    v_xor_b32 v31, s36, v2
    buffer_load_dwordx4 v31, s[8:11], s37 offen offset:2048 nt lds
    s_nop 0
    v_xor_b32 v31, s36, v3
    buffer_load_dwordx4 v31, s[8:11], s37 offen offset:3072 nt lds
    s_nop 0
    s_add_u32 m0, s26, s50
    s_nop 0
    buffer_load_dwordx4 v0, s[12:15], s24 offen offset:0 nt lds
    s_nop 0
    buffer_load_dwordx4 v1, s[12:15], s24 offen offset:1024 nt lds
    s_nop 0
    buffer_load_dwordx4 v2, s[12:15], s24 offen offset:2048 nt lds
    s_nop 0
    buffer_load_dwordx4 v3, s[12:15], s24 offen offset:3072 nt lds
    s_nop 0
    s_add_u32 s24, s24, 0x4000
    s_add_u32 s50, s50, 0x4000
    s_and_b32 s50, s50, 0xffff
    s_nop 0
    s_waitcnt vmcnt(20)
    v_mbcnt_lo_u32_b32 v29, -1, 0
    v_mbcnt_hi_u32_b32 v29, -1, v29
    v_bfe_u32 v29, v29, 3, 2
    s_add_u32 s32, s34, 0x0
    s_sub_u32 s32, s32, s52
    v_mov_b32 v30, s32
    s_add_u32 s32, s34, 0x0
    s_sub_u32 s32, s32, s52
    v_cmp_eq_u32 vcc, 1, v29
    v_mov_b32 v28, s32
    s_nop 0
    v_cndmask_b32 v30, v30, v28, vcc
    s_add_u32 s32, s26, 0x6000
    s_sub_u32 s32, s32, s52
    v_cmp_eq_u32 vcc, 2, v29
    v_mov_b32 v28, s32
    s_nop 0
    v_cndmask_b32 v30, v30, v28, vcc
    s_add_u32 s32, s26, 0x9000
    s_sub_u32 s32, s32, s52
    v_cmp_eq_u32 vcc, 3, v29
    v_mov_b32 v28, s32
    s_nop 0
    v_cndmask_b32 v30, v30, v28, vcc
    v_add_u32 v29, v6, v30
    ds_read_b128 a[0:3], v29 offset:0
    v_add_u32 v29, v7, v30
    ds_read_b128 a[4:7], v29 offset:0
    v_add_u32 v29, v8, v30
    ds_read_b128 a[8:11], v29 offset:0
    v_add_u32 v29, v9, v30
    ds_read_b128 a[12:15], v29 offset:0
    v_add_u32 v29, v10, v30
    ds_read_b128 a[16:19], v29 offset:0
    v_add_u32 v29, v11, v30
    ds_read_b128 a[20:23], v29 offset:0
    v_add_u32 v29, v12, v30
    ds_read_b128 a[24:27], v29 offset:0
    v_add_u32 v29, v13, v30
    ds_read_b128 a[28:31], v29 offset:0
    v_add_u32 v29, v6, v30
    ds_read_b128 a[32:35], v29 offset:256
    v_add_u32 v29, v7, v30
    ds_read_b128 a[36:39], v29 offset:256
    v_add_u32 v29, v8, v30
    ds_read_b128 a[40:43], v29 offset:256
    v_add_u32 v29, v9, v30
    ds_read_b128 a[44:47], v29 offset:256
    v_add_u32 v29, v10, v30
    ds_read_b128 a[48:51], v29 offset:256
    v_add_u32 v29, v11, v30
    ds_read_b128 a[52:55], v29 offset:256
    v_add_u32 v29, v12, v30
    ds_read_b128 a[56:59], v29 offset:256
    v_add_u32 v29, v13, v30
    ds_read_b128 a[60:63], v29 offset:256
    s_waitcnt vmcnt(4)
    v_mbcnt_lo_u32_b32 v29, -1, 0
    v_mbcnt_hi_u32_b32 v29, -1, v29
    v_bfe_u32 v29, v29, 3, 2
    s_add_u32 s32, s26, 0x10000
    s_sub_u32 s32, s32, s52
    v_mov_b32 v30, s32
    s_add_u32 s32, s26, 0x13000
    s_sub_u32 s32, s32, s52
    v_cmp_eq_u32 vcc, 1, v29
    v_mov_b32 v28, s32
    s_nop 0
    v_cndmask_b32 v30, v30, v28, vcc
    s_add_u32 s32, s26, 0x16000
    s_sub_u32 s32, s32, s52
    v_cmp_eq_u32 vcc, 2, v29
    v_mov_b32 v28, s32
    s_nop 0
    v_cndmask_b32 v30, v30, v28, vcc
    s_add_u32 s32, s26, 0x19000
    s_sub_u32 s32, s32, s52
    v_cmp_eq_u32 vcc, 3, v29
    v_mov_b32 v28, s32
    s_nop 0
    v_cndmask_b32 v30, v30, v28, vcc
    v_add_u32 v29, v6, v30
    ds_read_b128 a[64:67], v29 offset:0
    v_add_u32 v29, v7, v30
    ds_read_b128 a[68:71], v29 offset:0
    v_add_u32 v29, v8, v30
    ds_read_b128 a[72:75], v29 offset:0
    v_add_u32 v29, v9, v30
    ds_read_b128 a[76:79], v29 offset:0
    v_add_u32 v29, v10, v30
    ds_read_b128 a[80:83], v29 offset:0
    v_add_u32 v29, v11, v30
    ds_read_b128 a[84:87], v29 offset:0
    v_add_u32 v29, v12, v30
    ds_read_b128 a[88:91], v29 offset:0
    v_add_u32 v29, v13, v30
    ds_read_b128 a[92:95], v29 offset:0
    v_add_u32 v29, v6, v30
    ds_read_b128 a[96:99], v29 offset:256
    v_add_u32 v29, v7, v30
    ds_read_b128 a[100:103], v29 offset:256
    v_add_u32 v29, v8, v30
    ds_read_b128 a[104:107], v29 offset:256
    v_add_u32 v29, v9, v30
    ds_read_b128 a[108:111], v29 offset:256
    v_add_u32 v29, v10, v30
    ds_read_b128 a[112:115], v29 offset:256
    v_add_u32 v29, v11, v30
    ds_read_b128 a[116:119], v29 offset:256
    v_add_u32 v29, v12, v30
    ds_read_b128 a[120:123], v29 offset:256
    v_add_u32 v29, v13, v30
    ds_read_b128 a[124:127], v29 offset:256
    s_waitcnt lgkmcnt(0)
    s_barrier
    ds_read_b128 a[128:131], v6 offset:0
    ds_read_b128 a[132:135], v7 offset:0
    ds_read_b128 a[136:139], v8 offset:0
    ds_read_b128 a[140:143], v9 offset:0
    s_waitcnt lgkmcnt(3)
    v_mfma_f32_32x32x16_bf16 v[32:47], a[128:131], a[0:3], 0
    s_add_u32 m0, s49, s51
    v_mfma_f32_32x32x16_bf16 v[48:63], a[128:131], a[64:67], 0
    ds_read_b128 a[128:131], v10 offset:0
    buffer_load_dwordx4 v4, s[16:19], s25 offen offset:0 nt lds
    s_waitcnt lgkmcnt(3)
    v_mfma_f32_32x32x16_bf16 v[32:47], a[132:135], a[4:7], v[32:47]
    buffer_load_dwordx4 v5, s[16:19], s25 offen offset:1024 nt lds
    v_mfma_f32_32x32x16_bf16 v[48:63], a[132:135], a[68:71], v[48:63]
    ds_read_b128 a[132:135], v11 offset:0
    buffer_load_dwordx4 v4, s[16:19], s25 offen offset:2048 nt lds
    s_waitcnt lgkmcnt(3)
    v_mfma_f32_32x32x16_bf16 v[32:47], a[136:139], a[8:11], v[32:47]
    buffer_load_dwordx4 v5, s[16:19], s25 offen offset:3072 nt lds
    v_mfma_f32_32x32x16_bf16 v[48:63], a[136:139], a[72:75], v[48:63]
    ds_read_b128 a[136:139], v12 offset:0
    s_add_u32 s25, s25, 0x4000
    s_add_u32 s51, s51, 0x4000
    s_and_b32 s51, s51, 0xffff
    s_waitcnt lgkmcnt(3)
    v_mfma_f32_32x32x16_bf16 v[32:47], a[140:143], a[12:15], v[32:47]
    s_add_u32 m0, s26, s50
    v_mfma_f32_32x32x16_bf16 v[48:63], a[140:143], a[76:79], v[48:63]
    ds_read_b128 a[140:143], v13 offset:0
    buffer_load_dwordx4 v0, s[12:15], s24 offen offset:0 nt lds
    s_waitcnt lgkmcnt(3)
    v_mfma_f32_32x32x16_bf16 v[32:47], a[128:131], a[16:19], v[32:47]
    buffer_load_dwordx4 v1, s[12:15], s24 offen offset:1024 nt lds
    v_mfma_f32_32x32x16_bf16 v[48:63], a[128:131], a[80:83], v[48:63]
    ds_read_b128 a[128:131], v6 offset:256
    buffer_load_dwordx4 v2, s[12:15], s24 offen offset:2048 nt lds
    s_waitcnt lgkmcnt(3)
    v_mfma_f32_32x32x16_bf16 v[32:47], a[132:135], a[20:23], v[32:47]
    buffer_load_dwordx4 v3, s[12:15], s24 offen offset:3072 nt lds
    v_mfma_f32_32x32x16_bf16 v[48:63], a[132:135], a[84:87], v[48:63]
    ds_read_b128 a[132:135], v7 offset:256
    s_add_u32 s24, s24, 0x4000
    s_add_u32 s50, s50, 0x4000
    s_and_b32 s50, s50, 0xffff
    s_waitcnt lgkmcnt(3)
    v_mfma_f32_32x32x16_bf16 v[32:47], a[136:139], a[24:27], v[32:47]
    s_add_u32 m0, s49, s51
    v_mfma_f32_32x32x16_bf16 v[48:63], a[136:139], a[88:91], v[48:63]
    ds_read_b128 a[136:139], v8 offset:256
    buffer_load_dwordx4 v4, s[16:19], s25 offen offset:0 nt lds
    s_waitcnt lgkmcnt(3)
    v_mfma_f32_32x32x16_bf16 v[32:47], a[140:143], a[28:31], v[32:47]
    buffer_load_dwordx4 v5, s[16:19], s25 offen offset:1024 nt lds
    v_mfma_f32_32x32x16_bf16 v[48:63], a[140:143], a[92:95], v[48:63]
    ds_read_b128 a[140:143], v9 offset:256
    buffer_load_dwordx4 v4, s[16:19], s25 offen offset:2048 nt lds
    s_waitcnt lgkmcnt(3)
    v_mfma_f32_32x32x16_bf16 v[32:47], a[128:131], a[32:35], v[32:47]
    buffer_load_dwordx4 v5, s[16:19], s25 offen offset:3072 nt lds
    v_mfma_f32_32x32x16_bf16 v[48:63], a[128:131], a[96:99], v[48:63]
    ds_read_b128 a[128:131], v10 offset:256
    s_add_u32 s25, s25, 0x4000
    s_add_u32 s51, s51, 0x4000
    s_and_b32 s51, s51, 0xffff
    s_waitcnt lgkmcnt(3)
    v_mfma_f32_32x32x16_bf16 v[32:47], a[132:135], a[36:39], v[32:47]
    s_add_u32 m0, s26, s50
    v_mfma_f32_32x32x16_bf16 v[48:63], a[132:135], a[100:103], v[48:63]
    ds_read_b128 a[132:135], v11 offset:256
    buffer_load_dwordx4 v0, s[12:15], s24 offen offset:0 nt lds
    s_waitcnt lgkmcnt(3)
    v_mfma_f32_32x32x16_bf16 v[32:47], a[136:139], a[40:43], v[32:47]
    buffer_load_dwordx4 v1, s[12:15], s24 offen offset:1024 nt lds
    v_mfma_f32_32x32x16_bf16 v[48:63], a[136:139], a[104:107], v[48:63]
    ds_read_b128 a[136:139], v12 offset:256
    buffer_load_dwordx4 v2, s[12:15], s24 offen offset:2048 nt lds
    s_waitcnt lgkmcnt(3)
    v_mfma_f32_32x32x16_bf16 v[32:47], a[140:143], a[44:47], v[32:47]
    buffer_load_dwordx4 v3, s[12:15], s24 offen offset:3072 nt lds
    v_mfma_f32_32x32x16_bf16 v[48:63], a[140:143], a[108:111], v[48:63]
    ds_read_b128 a[140:143], v13 offset:256
    s_add_u32 s24, s24, 0x4000
    s_add_u32 s50, s50, 0x4000
    s_and_b32 s50, s50, 0xffff
    s_waitcnt lgkmcnt(3)
    v_mfma_f32_32x32x16_bf16 v[32:47], a[128:131], a[48:51], v[32:47]
    s_add_u32 s33, s52, 0x4000
    s_and_b32 s33, s33, 0xffff
    s_sub_u32 s54, s33, s52
    s_mov_b32 s52, s33
    v_add_u32 v6, s54, v6
    v_add_u32 v7, s54, v7
    v_add_u32 v8, s54, v8
    v_add_u32 v9, s54, v9
    v_add_u32 v10, s54, v10
    v_add_u32 v11, s54, v11
    v_add_u32 v12, s54, v12
    v_add_u32 v13, s54, v13
    v_mfma_f32_32x32x16_bf16 v[48:63], a[128:131], a[112:115], v[48:63]
    s_waitcnt lgkmcnt(2)
    v_mfma_f32_32x32x16_bf16 v[32:47], a[132:135], a[52:55], v[32:47]
    v_mfma_f32_32x32x16_bf16 v[48:63], a[132:135], a[116:119], v[48:63]
    s_waitcnt lgkmcnt(0)
    s_waitcnt vmcnt(16)
    s_barrier
    s_waitcnt lgkmcnt(0)
    v_mfma_f32_32x32x16_bf16 v[32:47], a[136:139], a[56:59], v[32:47]
    ds_read_b128 a[128:131], v6 offset:0
    ds_read_b128 a[132:135], v7 offset:0
    v_mfma_f32_32x32x16_bf16 v[48:63], a[136:139], a[120:123], v[48:63]
    s_waitcnt lgkmcnt(2)
    v_mfma_f32_32x32x16_bf16 v[32:47], a[140:143], a[60:63], v[32:47]
    ds_read_b128 a[136:139], v8 offset:0
    v_mfma_f32_32x32x16_bf16 v[48:63], a[140:143], a[124:127], v[48:63]
    ds_read_b128 a[140:143], v9 offset:0
    s_waitcnt lgkmcnt(3)
    v_mfma_f32_32x32x16_bf16 v[64:79], a[128:131], a[0:3], 0
    s_add_u32 m0, s49, s51
    v_mfma_f32_32x32x16_bf16 v[80:95], a[128:131], a[64:67], 0
    ds_read_b128 a[128:131], v10 offset:0
    buffer_load_dwordx4 v4, s[16:19], s25 offen offset:0 nt lds
    s_waitcnt lgkmcnt(3)
    v_mfma_f32_32x32x16_bf16 v[64:79], a[132:135], a[4:7], v[64:79]
    buffer_load_dwordx4 v5, s[16:19], s25 offen offset:1024 nt lds
    v_mfma_f32_32x32x16_bf16 v[80:95], a[132:135], a[68:71], v[80:95]
    ds_read_b128 a[132:135], v11 offset:0
    buffer_load_dwordx4 v4, s[16:19], s25 offen offset:2048 nt lds
    v_mul_f32 v32, s28, v32
    v_mul_f32 v33, s28, v33
    v_mul_f32 v34, s28, v34
    v_mul_f32 v35, s28, v35
    v_mul_f32 v36, s28, v36
    v_mul_f32 v37, s28, v37
    v_mul_f32 v38, s28, v38
    s_waitcnt lgkmcnt(3)
    v_mfma_f32_32x32x16_bf16 v[64:79], a[136:139], a[8:11], v[64:79]
    buffer_load_dwordx4 v5, s[16:19], s25 offen offset:3072 nt lds
    v_mul_f32 v39, s28, v39
    v_mul_f32 v40, s28, v40
    v_mul_f32 v41, s28, v41
    v_mul_f32 v42, s28, v42
    v_mfma_f32_32x32x16_bf16 v[80:95], a[136:139], a[72:75], v[80:95]
    ds_read_b128 a[136:139], v12 offset:0
    s_add_u32 s25, s25, 0x4000
    s_add_u32 s51, s51, 0x4000
    s_and_b32 s51, s51, 0xffff
    v_mul_f32 v43, s28, v43
    v_mul_f32 v44, s28, v44
    s_waitcnt lgkmcnt(3)
    v_mfma_f32_32x32x16_bf16 v[64:79], a[140:143], a[12:15], v[64:79]
    s_add_u32 m0, s26, s50
    v_mul_f32 v45, s28, v45
    v_mul_f32 v46, s28, v46
    v_mul_f32 v47, s28, v47
    v_max3_f32 v22, v32, v33, v34
    v_mfma_f32_32x32x16_bf16 v[80:95], a[140:143], a[76:79], v[80:95]
    ds_read_b128 a[140:143], v13 offset:0
    buffer_load_dwordx4 v0, s[12:15], s24 offen offset:0 nt lds
    v_max3_f32 v22, v22, v35, v36
    v_max3_f32 v22, v22, v37, v38
    s_waitcnt lgkmcnt(3)
    v_mfma_f32_32x32x16_bf16 v[64:79], a[128:131], a[16:19], v[64:79]
    buffer_load_dwordx4 v1, s[12:15], s24 offen offset:1024 nt lds
    v_max3_f32 v22, v22, v39, v40
    v_max3_f32 v22, v22, v41, v42
    v_max3_f32 v22, v22, v43, v44
    v_max3_f32 v22, v22, v45, v46
    v_mfma_f32_32x32x16_bf16 v[80:95], a[128:131], a[80:83], v[80:95]
    ds_read_b128 a[128:131], v6 offset:256
    buffer_load_dwordx4 v2, s[12:15], s24 offen offset:2048 nt lds
    v_max_f32 v22, v22, v47
    v_mov_b32 v28, v22
    s_nop 1
    v_permlane32_swap_b32 v22, v28
    s_nop 1
    v_max_f32 v18, v22, v28
    v_mov_b32 v20, 0
    s_waitcnt lgkmcnt(3)
    v_mfma_f32_32x32x16_bf16 v[64:79], a[132:135], a[20:23], v[64:79]
    v_mfma_f32_32x32x16_bf16 v[80:95], a[132:135], a[84:87], v[80:95]
    ds_read_b128 a[132:135], v7 offset:256
    buffer_load_dwordx4 v3, s[12:15], s24 offen offset:3072 nt lds
    s_waitcnt lgkmcnt(3)
    v_mfma_f32_32x32x16_bf16 v[64:79], a[136:139], a[24:27], v[64:79]
    s_add_u32 s24, s24, 0x4000
    s_add_u32 s50, s50, 0x4000
    s_and_b32 s50, s50, 0xffff
    v_sub_f32 v32, v32, v18
    v_sub_f32 v33, v33, v18
    v_sub_f32 v34, v34, v18
    v_sub_f32 v35, v35, v18
    v_mfma_f32_32x32x16_bf16 v[80:95], a[136:139], a[88:91], v[80:95]
    ds_read_b128 a[136:139], v8 offset:256
    v_sub_f32 v36, v36, v18
    v_sub_f32 v37, v37, v18
    v_sub_f32 v38, v38, v18
    s_waitcnt lgkmcnt(3)
    v_mfma_f32_32x32x16_bf16 v[64:79], a[140:143], a[28:31], v[64:79]
    v_sub_f32 v39, v39, v18
    v_sub_f32 v40, v40, v18
    v_sub_f32 v41, v41, v18
    v_sub_f32 v42, v42, v18
    v_sub_f32 v43, v43, v18
    v_mfma_f32_32x32x16_bf16 v[80:95], a[140:143], a[92:95], v[80:95]
    ds_read_b128 a[140:143], v9 offset:256
    v_sub_f32 v44, v44, v18
    v_sub_f32 v45, v45, v18
    v_sub_f32 v46, v46, v18
    s_waitcnt lgkmcnt(3)
    v_mfma_f32_32x32x16_bf16 v[64:79], a[128:131], a[32:35], v[64:79]
    v_sub_f32 v47, v47, v18
    v_mul_f32 v48, s28, v48
    v_mul_f32 v49, s28, v49
    v_mul_f32 v50, s28, v50
    v_mul_f32 v51, s28, v51
    v_mfma_f32_32x32x16_bf16 v[80:95], a[128:131], a[96:99], v[80:95]
    ds_read_b128 a[128:131], v10 offset:256
    v_mul_f32 v52, s28, v52
    v_mul_f32 v53, s28, v53
    v_mul_f32 v54, s28, v54
    s_waitcnt lgkmcnt(3)
    v_mfma_f32_32x32x16_bf16 v[64:79], a[132:135], a[36:39], v[64:79]
    v_mul_f32 v55, s28, v55
    v_mul_f32 v56, s28, v56
    v_mul_f32 v57, s28, v57
    v_mul_f32 v58, s28, v58
    v_mul_f32 v59, s28, v59
    v_mfma_f32_32x32x16_bf16 v[80:95], a[132:135], a[100:103], v[80:95]
    ds_read_b128 a[132:135], v11 offset:256
    v_mul_f32 v60, s28, v60
    v_mul_f32 v61, s28, v61
    v_mul_f32 v62, s28, v62
    s_waitcnt lgkmcnt(3)
    v_mfma_f32_32x32x16_bf16 v[64:79], a[136:139], a[40:43], v[64:79]
    v_mul_f32 v63, s28, v63
    v_max3_f32 v22, v48, v49, v50
    v_max3_f32 v22, v22, v51, v52
    v_max3_f32 v22, v22, v53, v54
    v_max3_f32 v22, v22, v55, v56
    v_mfma_f32_32x32x16_bf16 v[80:95], a[136:139], a[104:107], v[80:95]
    ds_read_b128 a[136:139], v12 offset:256
    v_max3_f32 v22, v22, v57, v58
    v_max3_f32 v22, v22, v59, v60
    v_max3_f32 v22, v22, v61, v62
    s_waitcnt lgkmcnt(3)
    v_mfma_f32_32x32x16_bf16 v[64:79], a[140:143], a[44:47], v[64:79]
    s_waitcnt vmcnt(20)
    s_barrier
    v_max_f32 v22, v22, v63
    v_mov_b32 v28, v22
    s_nop 1
    v_permlane32_swap_b32 v22, v28
    s_nop 1
    v_max_f32 v19, v22, v28
    v_mov_b32 v21, 0
    v_mfma_f32_32x32x16_bf16 v[80:95], a[140:143], a[108:111], v[80:95]
    ds_read_b128 a[140:143], v13 offset:256
    s_waitcnt lgkmcnt(3)
    v_mfma_f32_32x32x16_bf16 v[64:79], a[128:131], a[48:51], v[64:79]
    ds_read_b64_tr_b16 a[144:145], v14 offset:0
    v_sub_f32 v48, v48, v19
    v_mfma_f32_32x32x16_bf16 v[80:95], a[128:131], a[112:115], v[80:95]
    ds_read_b64_tr_b16 a[146:147], v14 offset:4096
    v_sub_f32 v49, v49, v19
    v_sub_f32 v50, v50, v19
    v_sub_f32 v51, v51, v19
    s_waitcnt lgkmcnt(4)
    v_mfma_f32_32x32x16_bf16 v[64:79], a[132:135], a[52:55], v[64:79]
    ds_read_b64_tr_b16 a[148:149], v15 offset:0
    v_sub_f32 v52, v52, v19
    v_sub_f32 v53, v53, v19
    v_sub_f32 v54, v54, v19
    v_sub_f32 v55, v55, v19
    v_mfma_f32_32x32x16_bf16 v[80:95], a[132:135], a[116:119], v[80:95]
    ds_read_b64_tr_b16 a[150:151], v15 offset:4096
    v_sub_f32 v56, v56, v19
    v_sub_f32 v57, v57, v19
    v_sub_f32 v58, v58, v19
    s_waitcnt lgkmcnt(5)
    v_mfma_f32_32x32x16_bf16 v[64:79], a[136:139], a[56:59], v[64:79]
    ds_read_b64_tr_b16 a[152:153], v16 offset:0
    v_sub_f32 v59, v59, v19
    v_sub_f32 v60, v60, v19
    v_sub_f32 v61, v61, v19
    v_sub_f32 v62, v62, v19
    v_mfma_f32_32x32x16_bf16 v[80:95], a[136:139], a[120:123], v[80:95]
    ds_read_b64_tr_b16 a[154:155], v16 offset:4096
    v_sub_f32 v63, v63, v19
    v_exp_f32 v32, v32
    s_waitcnt lgkmcnt(6)
    v_mfma_f32_32x32x16_bf16 v[64:79], a[140:143], a[60:63], v[64:79]
    ds_read_b64_tr_b16 a[156:157], v17 offset:0
    v_exp_f32 v33, v33
    v_add_f32 v20, v20, v32
    v_add_f32 v20, v20, v33
    v_mfma_f32_32x32x16_bf16 v[80:95], a[140:143], a[124:127], v[80:95]
    ds_read_b64_tr_b16 a[158:159], v17 offset:4096
    v_cvt_pk_bf16_f32 v32, v32, v33
    v_exp_f32 v34, v34
    v_exp_f32 v35, v35
    v_add_f32 v20, v20, v34
    v_add_f32 v20, v20, v35
    v_cvt_pk_bf16_f32 v33, v34, v35
    v_exp_f32 v36, v36
    v_exp_f32 v37, v37
    v_add_f32 v20, v20, v36
    v_add_f32 v20, v20, v37
    v_cvt_pk_bf16_f32 v34, v36, v37
    v_exp_f32 v38, v38
    v_exp_f32 v39, v39
    v_add_f32 v20, v20, v38
    v_add_f32 v20, v20, v39
    v_cvt_pk_bf16_f32 v35, v38, v39
    v_exp_f32 v48, v48
    v_exp_f32 v49, v49
    v_add_f32 v21, v21, v48
    v_add_f32 v21, v21, v49
    v_cvt_pk_bf16_f32 v48, v48, v49
    v_exp_f32 v50, v50
    v_exp_f32 v51, v51
    v_add_f32 v21, v21, v50
    v_add_f32 v21, v21, v51
    v_cvt_pk_bf16_f32 v49, v50, v51
    v_exp_f32 v52, v52
    v_exp_f32 v53, v53
    v_add_f32 v21, v21, v52
    v_add_f32 v21, v21, v53
    v_cvt_pk_bf16_f32 v50, v52, v53
    v_exp_f32 v54, v54
    v_exp_f32 v55, v55
    v_add_f32 v21, v21, v54
    v_add_f32 v21, v21, v55
    v_cvt_pk_bf16_f32 v51, v54, v55
    v_exp_f32 v40, v40
    v_exp_f32 v41, v41
    v_add_f32 v20, v20, v40
    v_add_f32 v20, v20, v41
    v_cvt_pk_bf16_f32 v40, v40, v41
    v_exp_f32 v42, v42
    v_exp_f32 v43, v43
    v_add_f32 v20, v20, v42
    v_add_f32 v20, v20, v43
    v_cvt_pk_bf16_f32 v41, v42, v43
    v_exp_f32 v44, v44
    v_exp_f32 v45, v45
    v_add_f32 v20, v20, v44
    v_add_f32 v20, v20, v45
    v_cvt_pk_bf16_f32 v42, v44, v45
    v_exp_f32 v46, v46
    v_exp_f32 v47, v47
    v_add_f32 v20, v20, v46
    v_add_f32 v20, v20, v47
    v_cvt_pk_bf16_f32 v43, v46, v47
    v_exp_f32 v56, v56
    v_exp_f32 v57, v57
    v_add_f32 v21, v21, v56
    v_add_f32 v21, v21, v57
    v_cvt_pk_bf16_f32 v56, v56, v57
    v_exp_f32 v58, v58
    v_exp_f32 v59, v59
    v_add_f32 v21, v21, v58
    v_add_f32 v21, v21, v59
    v_cvt_pk_bf16_f32 v57, v58, v59
    v_exp_f32 v60, v60
    v_exp_f32 v61, v61
    v_add_f32 v21, v21, v60
    v_add_f32 v21, v21, v61
    v_cvt_pk_bf16_f32 v58, v60, v61
    v_exp_f32 v62, v62
    v_exp_f32 v63, v63
    v_add_f32 v21, v21, v62
    v_add_f32 v21, v21, v63
    v_cvt_pk_bf16_f32 v59, v62, v63
    s_nop 1
L_body:
    s_waitcnt lgkmcnt(6)
    v_mfma_f32_32x32x16_bf16 v[96:111], a[144:147], v[32:35], 0
    s_add_u32 s33, s52, 0x4000
    s_and_b32 s33, s33, 0xffff
    s_sub_u32 s54, s33, s52
    s_mov_b32 s52, s33
    v_add_u32 v6, s54, v6
    v_mfma_f32_32x32x16_bf16 v[112:127], a[144:147], v[48:51], 0
    ds_read_b64_tr_b16 a[144:145], v14 offset:256
    ds_read_b64_tr_b16 a[146:147], v14 offset:4352
    v_add_u32 v7, s54, v7
    v_add_u32 v8, s54, v8
    s_waitcnt lgkmcnt(6)
    v_mfma_f32_32x32x16_bf16 v[128:143], a[148:151], v[32:35], 0
    v_add_u32 v9, s54, v9
    v_add_u32 v10, s54, v10
    v_add_u32 v11, s54, v11
    v_add_u32 v12, s54, v12
    v_add_u32 v13, s54, v13
    v_mfma_f32_32x32x16_bf16 v[144:159], a[148:151], v[48:51], 0
    ds_read_b64_tr_b16 a[148:149], v15 offset:256
    ds_read_b64_tr_b16 a[150:151], v15 offset:4352
    s_waitcnt lgkmcnt(6)
    v_mfma_f32_32x32x16_bf16 v[160:175], a[152:155], v[32:35], 0
    v_mfma_f32_32x32x16_bf16 v[176:191], a[152:155], v[48:51], 0
    ds_read_b64_tr_b16 a[152:153], v16 offset:256
    ds_read_b64_tr_b16 a[154:155], v16 offset:4352
    s_waitcnt lgkmcnt(6)
    v_mfma_f32_32x32x16_bf16 v[192:207], a[156:159], v[32:35], 0
    v_fma_f32 v64, v64, s28, -v18
    v_fma_f32 v65, v65, s28, -v18
    v_fma_f32 v66, v66, s28, -v18
    v_fma_f32 v67, v67, s28, -v18
    v_max3_f32 v22, v64, v65, v66
    v_fma_f32 v68, v68, s28, -v18
    v_fma_f32 v69, v69, s28, -v18
    v_max3_f32 v22, v22, v67, v68
    v_fma_f32 v70, v70, s28, -v18
    v_fma_f32 v71, v71, s28, -v18
    v_mfma_f32_32x32x16_bf16 v[208:223], a[156:159], v[48:51], 0
    ds_read_b64_tr_b16 a[156:157], v17 offset:256
    ds_read_b64_tr_b16 a[158:159], v17 offset:4352
    v_max3_f32 v22, v22, v69, v70
    v_fma_f32 v72, v72, s28, -v18
    s_waitcnt lgkmcnt(6)
    v_mfma_f32_32x32x16_bf16 v[224:239], a[144:147], v[32:35], 0
    v_fma_f32 v73, v73, s28, -v18
    v_max3_f32 v22, v22, v71, v72
    v_fma_f32 v74, v74, s28, -v18
    v_fma_f32 v75, v75, s28, -v18
    v_max3_f32 v22, v22, v73, v74
    v_mfma_f32_32x32x16_bf16 v[240:255], a[144:147], v[48:51], 0
    ds_read_b64_tr_b16 a[144:145], v14 offset:8192
    ds_read_b64_tr_b16 a[146:147], v14 offset:12288
    v_fma_f32 v76, v76, s28, -v18
    v_fma_f32 v77, v77, s28, -v18
    s_waitcnt lgkmcnt(6)
    v_mfma_f32_32x32x16_bf16 a[160:175], a[148:151], v[32:35], 0
    s_waitcnt vmcnt(8)
    s_barrier
    v_max3_f32 v22, v22, v75, v76
    v_fma_f32 v78, v78, s28, -v18
    v_fma_f32 v79, v79, s28, -v18
    v_mfma_f32_32x32x16_bf16 a[176:191], a[148:151], v[48:51], 0
    ds_read_b64_tr_b16 a[148:149], v15 offset:8192
    ds_read_b64_tr_b16 a[150:151], v15 offset:12288
    s_add_u32 m0, s49, s51
    v_max3_f32 v22, v22, v77, v78
    s_waitcnt lgkmcnt(6)
    v_mfma_f32_32x32x16_bf16 a[192:207], a[152:155], v[32:35], 0
    buffer_load_dwordx4 v4, s[16:19], s25 offen offset:0 nt lds
    v_fma_f32 v80, v80, s28, -v19
    v_fma_f32 v81, v81, s28, -v19
    v_max3_f32 v22, v22, v79, v80
    v_fma_f32 v82, v82, s28, -v19
    v_mfma_f32_32x32x16_bf16 a[208:223], a[152:155], v[48:51], 0
    ds_read_b64_tr_b16 a[152:153], v16 offset:8192
    ds_read_b64_tr_b16 a[154:155], v16 offset:12288
    buffer_load_dwordx4 v5, s[16:19], s25 offen offset:1024 nt lds
    v_fma_f32 v83, v83, s28, -v19
    s_waitcnt lgkmcnt(6)
    v_mfma_f32_32x32x16_bf16 a[224:239], a[156:159], v[32:35], 0
    buffer_load_dwordx4 v4, s[16:19], s25 offen offset:2048 nt lds
    v_max3_f32 v22, v22, v81, v82
    v_fma_f32 v84, v84, s28, -v19
    v_fma_f32 v85, v85, s28, -v19
    v_max3_f32 v22, v22, v83, v84
    v_mfma_f32_32x32x16_bf16 a[240:255], a[156:159], v[48:51], 0
    ds_read_b64_tr_b16 a[156:157], v17 offset:8192
    ds_read_b64_tr_b16 a[158:159], v17 offset:12288
    buffer_load_dwordx4 v5, s[16:19], s25 offen offset:3072 nt lds
    v_fma_f32 v86, v86, s28, -v19
    s_waitcnt lgkmcnt(6)
    v_mfma_f32_32x32x16_bf16 v[96:111], a[144:147], v[40:43], v[96:111]
    s_add_u32 s25, s25, 0x4000
    s_add_u32 s51, s51, 0x4000
    s_and_b32 s51, s51, 0xffff
    v_fma_f32 v87, v87, s28, -v19
    v_max3_f32 v22, v22, v85, v86
    v_fma_f32 v88, v88, s28, -v19
    v_fma_f32 v89, v89, s28, -v19
    v_mfma_f32_32x32x16_bf16 v[112:127], a[144:147], v[56:59], v[112:127]
    ds_read_b64_tr_b16 a[144:145], v14 offset:8448
    ds_read_b64_tr_b16 a[146:147], v14 offset:12544
    s_add_u32 m0, s26, s50
    v_max3_f32 v22, v22, v87, v88
    s_waitcnt lgkmcnt(6)
    v_mfma_f32_32x32x16_bf16 v[128:143], a[148:151], v[40:43], v[128:143]
    buffer_load_dwordx4 v0, s[12:15], s24 offen offset:0 nt lds
    v_fma_f32 v90, v90, s28, -v19
    v_fma_f32 v91, v91, s28, -v19
    v_max3_f32 v22, v22, v89, v90
    v_fma_f32 v92, v92, s28, -v19
    v_mfma_f32_32x32x16_bf16 v[144:159], a[148:151], v[56:59], v[144:159]
    ds_read_b64_tr_b16 a[148:149], v15 offset:8448
    ds_read_b64_tr_b16 a[150:151], v15 offset:12544
    buffer_load_dwordx4 v1, s[12:15], s24 offen offset:1024 nt lds
    v_fma_f32 v93, v93, s28, -v19
    s_waitcnt lgkmcnt(6)
    v_mfma_f32_32x32x16_bf16 v[160:175], a[152:155], v[40:43], v[160:175]
    buffer_load_dwordx4 v2, s[12:15], s24 offen offset:2048 nt lds
    v_max3_f32 v22, v22, v91, v92
    v_fma_f32 v94, v94, s28, -v19
    v_fma_f32 v95, v95, s28, -v19
    v_max3_f32 v22, v22, v93, v94
    v_mfma_f32_32x32x16_bf16 v[176:191], a[152:155], v[56:59], v[176:191]
    ds_read_b64_tr_b16 a[152:153], v16 offset:8448
    ds_read_b64_tr_b16 a[154:155], v16 offset:12544
    buffer_load_dwordx4 v3, s[12:15], s24 offen offset:3072 nt lds
    v_max3_f32 v22, v22, v95, v95
    s_waitcnt lgkmcnt(6)
    v_mfma_f32_32x32x16_bf16 v[192:207], a[156:159], v[40:43], v[192:207]
    s_add_u32 s24, s24, 0x4000
    s_add_u32 s50, s50, 0x4000
    s_and_b32 s50, s50, 0xffff
    v_mfma_f32_32x32x16_bf16 v[208:223], a[156:159], v[56:59], v[208:223]
    ds_read_b64_tr_b16 a[156:157], v17 offset:8448
    ds_read_b64_tr_b16 a[158:159], v17 offset:12544
    s_waitcnt lgkmcnt(6)
    v_mfma_f32_32x32x16_bf16 v[224:239], a[144:147], v[40:43], v[224:239]
    v_mfma_f32_32x32x16_bf16 v[240:255], a[144:147], v[56:59], v[240:255]
    s_waitcnt lgkmcnt(4)
    v_mfma_f32_32x32x16_bf16 a[160:175], a[148:151], v[40:43], a[160:175]
    v_mfma_f32_32x32x16_bf16 a[176:191], a[148:151], v[56:59], a[176:191]
    s_waitcnt lgkmcnt(2)
    v_mfma_f32_32x32x16_bf16 a[192:207], a[152:155], v[40:43], a[192:207]
    ds_read_b128 a[128:131], v6 offset:0
    v_mfma_f32_32x32x16_bf16 a[208:223], a[152:155], v[56:59], a[208:223]
    ds_read_b128 a[132:135], v7 offset:0
    s_waitcnt lgkmcnt(2)
    v_mfma_f32_32x32x16_bf16 a[224:239], a[156:159], v[40:43], a[224:239]
    ds_read_b128 a[136:139], v8 offset:0
    v_mfma_f32_32x32x16_bf16 a[240:255], a[156:159], v[56:59], a[240:255]
    ds_read_b128 a[140:143], v9 offset:0
    v_cmp_lt_f32 vcc, 0x41000000, v22
    s_cbranch_vccz L_back_0
    s_call_b64 s[40:41], L_slow_1
L_back_0:
    s_mov_b32 s27, 0
L_loop:
    s_waitcnt lgkmcnt(3)
    v_mfma_f32_32x32x16_bf16 v[32:47], a[128:131], a[0:3], 0
    s_add_u32 s33, s53, 0x4000
    s_and_b32 s33, s33, 0xffff
    s_sub_u32 s54, s33, s53
    s_mov_b32 s53, s33
    v_add_u32 v14, s54, v14
    v_mfma_f32_32x32x16_bf16 v[48:63], a[128:131], a[64:67], 0
    ds_read_b128 a[128:131], v10 offset:0
    v_add_u32 v15, s54, v15
    v_add_u32 v16, s54, v16
    v_add_u32 v17, s54, v17
    s_waitcnt lgkmcnt(3)
    v_mfma_f32_32x32x16_bf16 v[32:47], a[132:135], a[4:7], v[32:47]
    v_exp_f32 v64, v64
    v_exp_f32 v65, v65
    v_add_f32 v20, v20, v64
    v_mfma_f32_32x32x16_bf16 v[48:63], a[132:135], a[68:71], v[48:63]
    ds_read_b128 a[132:135], v11 offset:0
    v_add_f32 v20, v20, v65
    v_cvt_pk_bf16_f32 v64, v64, v65
    s_waitcnt lgkmcnt(3)
    v_mfma_f32_32x32x16_bf16 v[32:47], a[136:139], a[8:11], v[32:47]
    v_exp_f32 v66, v66
    v_exp_f32 v67, v67
    v_add_f32 v20, v20, v66
    v_add_f32 v20, v20, v67
    v_mfma_f32_32x32x16_bf16 v[48:63], a[136:139], a[72:75], v[48:63]
    ds_read_b128 a[136:139], v12 offset:0
    v_cvt_pk_bf16_f32 v65, v66, v67
    v_exp_f32 v68, v68
    s_waitcnt lgkmcnt(3)
    v_mfma_f32_32x32x16_bf16 v[32:47], a[140:143], a[12:15], v[32:47]
    v_exp_f32 v69, v69
    v_add_f32 v20, v20, v68
    v_add_f32 v20, v20, v69
    v_cvt_pk_bf16_f32 v66, v68, v69
    v_mfma_f32_32x32x16_bf16 v[48:63], a[140:143], a[76:79], v[48:63]
    ds_read_b128 a[140:143], v13 offset:0
    v_exp_f32 v70, v70
    s_waitcnt lgkmcnt(3)
    v_mfma_f32_32x32x16_bf16 v[32:47], a[128:131], a[16:19], v[32:47]
    v_exp_f32 v71, v71
    v_add_f32 v20, v20, v70
    v_add_f32 v20, v20, v71
    v_cvt_pk_bf16_f32 v67, v70, v71
    v_mfma_f32_32x32x16_bf16 v[48:63], a[128:131], a[80:83], v[48:63]
    ds_read_b128 a[128:131], v6 offset:256
    v_exp_f32 v80, v80
    v_exp_f32 v81, v81
    s_waitcnt lgkmcnt(3)
    v_mfma_f32_32x32x16_bf16 v[32:47], a[132:135], a[20:23], v[32:47]
    v_add_f32 v21, v21, v80
    v_add_f32 v21, v21, v81
    v_cvt_pk_bf16_f32 v80, v80, v81
    v_exp_f32 v82, v82
    v_mfma_f32_32x32x16_bf16 v[48:63], a[132:135], a[84:87], v[48:63]
    ds_read_b128 a[132:135], v7 offset:256
    v_exp_f32 v83, v83
    v_add_f32 v21, v21, v82
    s_waitcnt lgkmcnt(3)
    v_mfma_f32_32x32x16_bf16 v[32:47], a[136:139], a[24:27], v[32:47]
    v_add_f32 v21, v21, v83
    v_cvt_pk_bf16_f32 v81, v82, v83
    v_exp_f32 v84, v84
    v_mfma_f32_32x32x16_bf16 v[48:63], a[136:139], a[88:91], v[48:63]
    ds_read_b128 a[136:139], v8 offset:256
    v_exp_f32 v85, v85
    v_add_f32 v21, v21, v84
    v_add_f32 v21, v21, v85
    s_waitcnt lgkmcnt(3)
    v_mfma_f32_32x32x16_bf16 v[32:47], a[140:143], a[28:31], v[32:47]
    v_cvt_pk_bf16_f32 v82, v84, v85
    v_exp_f32 v86, v86
    v_exp_f32 v87, v87
    v_mfma_f32_32x32x16_bf16 v[48:63], a[140:143], a[92:95], v[48:63]
    ds_read_b128 a[140:143], v9 offset:256
    v_add_f32 v21, v21, v86
    v_add_f32 v21, v21, v87
    v_cvt_pk_bf16_f32 v83, v86, v87
    s_waitcnt lgkmcnt(3)
    v_mfma_f32_32x32x16_bf16 v[32:47], a[128:131], a[32:35], v[32:47]
    v_exp_f32 v72, v72
    v_exp_f32 v73, v73
    v_add_f32 v20, v20, v72
    v_mfma_f32_32x32x16_bf16 v[48:63], a[128:131], a[96:99], v[48:63]
    ds_read_b128 a[128:131], v10 offset:256
    v_add_f32 v20, v20, v73
    v_cvt_pk_bf16_f32 v72, v72, v73
    s_waitcnt lgkmcnt(3)
    v_mfma_f32_32x32x16_bf16 v[32:47], a[132:135], a[36:39], v[32:47]
    v_exp_f32 v74, v74
    v_exp_f32 v75, v75
    v_add_f32 v20, v20, v74
    v_add_f32 v20, v20, v75
    v_mfma_f32_32x32x16_bf16 v[48:63], a[132:135], a[100:103], v[48:63]
    ds_read_b128 a[132:135], v11 offset:256
    v_cvt_pk_bf16_f32 v73, v74, v75
    v_exp_f32 v76, v76
    s_waitcnt lgkmcnt(3)
    v_mfma_f32_32x32x16_bf16 v[32:47], a[136:139], a[40:43], v[32:47]
    v_exp_f32 v77, v77
    v_add_f32 v20, v20, v76
    v_add_f32 v20, v20, v77
    v_cvt_pk_bf16_f32 v74, v76, v77
    v_mfma_f32_32x32x16_bf16 v[48:63], a[136:139], a[104:107], v[48:63]
    ds_read_b128 a[136:139], v12 offset:256
    v_exp_f32 v78, v78
    s_waitcnt lgkmcnt(3)
    v_mfma_f32_32x32x16_bf16 v[32:47], a[140:143], a[44:47], v[32:47]
    v_exp_f32 v79, v79
    v_add_f32 v20, v20, v78
    v_add_f32 v20, v20, v79
    v_cvt_pk_bf16_f32 v75, v78, v79
    v_mfma_f32_32x32x16_bf16 v[48:63], a[140:143], a[108:111], v[48:63]
    ds_read_b128 a[140:143], v13 offset:256
    v_exp_f32 v88, v88
    v_exp_f32 v89, v89
    s_waitcnt lgkmcnt(3)
    v_mfma_f32_32x32x16_bf16 v[32:47], a[128:131], a[48:51], v[32:47]
    ds_read_b64_tr_b16 a[144:145], v14 offset:0
    v_add_f32 v21, v21, v88
    v_add_f32 v21, v21, v89
    v_cvt_pk_bf16_f32 v88, v88, v89
    v_mfma_f32_32x32x16_bf16 v[48:63], a[128:131], a[112:115], v[48:63]
    ds_read_b64_tr_b16 a[146:147], v14 offset:4096
    v_exp_f32 v90, v90
    v_exp_f32 v91, v91
    s_waitcnt lgkmcnt(4)
    v_mfma_f32_32x32x16_bf16 v[32:47], a[132:135], a[52:55], v[32:47]
    ds_read_b64_tr_b16 a[148:149], v15 offset:0
    v_add_f32 v21, v21, v90
    v_add_f32 v21, v21, v91
    v_cvt_pk_bf16_f32 v89, v90, v91
    v_mfma_f32_32x32x16_bf16 v[48:63], a[132:135], a[116:119], v[48:63]
    ds_read_b64_tr_b16 a[150:151], v15 offset:4096
    v_exp_f32 v92, v92
    v_exp_f32 v93, v93
    s_waitcnt lgkmcnt(5)
    v_mfma_f32_32x32x16_bf16 v[32:47], a[136:139], a[56:59], v[32:47]
    ds_read_b64_tr_b16 a[152:153], v16 offset:0
    v_add_f32 v21, v21, v92
    v_add_f32 v21, v21, v93
    v_cvt_pk_bf16_f32 v90, v92, v93
    v_mfma_f32_32x32x16_bf16 v[48:63], a[136:139], a[120:123], v[48:63]
    ds_read_b64_tr_b16 a[154:155], v16 offset:4096
    v_exp_f32 v94, v94
    v_exp_f32 v95, v95
    s_waitcnt lgkmcnt(6)
    v_mfma_f32_32x32x16_bf16 v[32:47], a[140:143], a[60:63], v[32:47]
    ds_read_b64_tr_b16 a[156:157], v17 offset:0
    v_add_f32 v21, v21, v94
    v_add_f32 v21, v21, v95
    v_cvt_pk_bf16_f32 v91, v94, v95
    v_mfma_f32_32x32x16_bf16 v[48:63], a[140:143], a[124:127], v[48:63]
    ds_read_b64_tr_b16 a[158:159], v17 offset:4096
    s_waitcnt lgkmcnt(6)
    v_mfma_f32_32x32x16_bf16 v[96:111], a[144:147], v[64:67], v[96:111]
    s_add_u32 s33, s52, 0x4000
    s_and_b32 s33, s33, 0xffff
    s_sub_u32 s54, s33, s52
    s_mov_b32 s52, s33
    v_add_u32 v6, s54, v6
    v_mfma_f32_32x32x16_bf16 v[112:127], a[144:147], v[80:83], v[112:127]
    ds_read_b64_tr_b16 a[144:145], v14 offset:256
    ds_read_b64_tr_b16 a[146:147], v14 offset:4352
    v_add_u32 v7, s54, v7
    v_add_u32 v8, s54, v8
    s_waitcnt lgkmcnt(6)
    v_mfma_f32_32x32x16_bf16 v[128:143], a[148:151], v[64:67], v[128:143]
    v_add_u32 v9, s54, v9
    v_add_u32 v10, s54, v10
    v_add_u32 v11, s54, v11
    v_add_u32 v12, s54, v12
    v_add_u32 v13, s54, v13
    v_mfma_f32_32x32x16_bf16 v[144:159], a[148:151], v[80:83], v[144:159]
    ds_read_b64_tr_b16 a[148:149], v15 offset:256
    ds_read_b64_tr_b16 a[150:151], v15 offset:4352
    s_waitcnt lgkmcnt(6)
    v_mfma_f32_32x32x16_bf16 v[160:175], a[152:155], v[64:67], v[160:175]
    v_mfma_f32_32x32x16_bf16 v[176:191], a[152:155], v[80:83], v[176:191]
    ds_read_b64_tr_b16 a[152:153], v16 offset:256
    ds_read_b64_tr_b16 a[154:155], v16 offset:4352
    s_waitcnt lgkmcnt(6)
    v_mfma_f32_32x32x16_bf16 v[192:207], a[156:159], v[64:67], v[192:207]
    v_fma_f32 v32, v32, s28, -v18
    v_fma_f32 v33, v33, s28, -v18
    v_fma_f32 v34, v34, s28, -v18
    v_fma_f32 v35, v35, s28, -v18
    v_max3_f32 v22, v32, v33, v34
    v_fma_f32 v36, v36, s28, -v18
    v_fma_f32 v37, v37, s28, -v18
    v_max3_f32 v22, v22, v35, v36
    v_fma_f32 v38, v38, s28, -v18
    v_fma_f32 v39, v39, s28, -v18
    v_mfma_f32_32x32x16_bf16 v[208:223], a[156:159], v[80:83], v[208:223]
    ds_read_b64_tr_b16 a[156:157], v17 offset:256
    ds_read_b64_tr_b16 a[158:159], v17 offset:4352
    v_max3_f32 v22, v22, v37, v38
    v_fma_f32 v40, v40, s28, -v18
    s_waitcnt lgkmcnt(6)
    v_mfma_f32_32x32x16_bf16 v[224:239], a[144:147], v[64:67], v[224:239]
    v_fma_f32 v41, v41, s28, -v18
    v_max3_f32 v22, v22, v39, v40
    v_fma_f32 v42, v42, s28, -v18
    v_fma_f32 v43, v43, s28, -v18
    v_max3_f32 v22, v22, v41, v42
    v_mfma_f32_32x32x16_bf16 v[240:255], a[144:147], v[80:83], v[240:255]
    ds_read_b64_tr_b16 a[144:145], v14 offset:8192
    ds_read_b64_tr_b16 a[146:147], v14 offset:12288
    v_fma_f32 v44, v44, s28, -v18
    v_fma_f32 v45, v45, s28, -v18
    s_waitcnt lgkmcnt(6)
    v_mfma_f32_32x32x16_bf16 a[160:175], a[148:151], v[64:67], a[160:175]
    s_waitcnt vmcnt(12)
    s_barrier
    v_max3_f32 v22, v22, v43, v44
    v_fma_f32 v46, v46, s28, -v18
    v_fma_f32 v47, v47, s28, -v18
    v_mfma_f32_32x32x16_bf16 a[176:191], a[148:151], v[80:83], a[176:191]
    ds_read_b64_tr_b16 a[148:149], v15 offset:8192
    ds_read_b64_tr_b16 a[150:151], v15 offset:12288
    s_add_u32 m0, s49, s51
    v_max3_f32 v22, v22, v45, v46
    s_waitcnt lgkmcnt(6)
    v_mfma_f32_32x32x16_bf16 a[192:207], a[152:155], v[64:67], a[192:207]
    buffer_load_dwordx4 v4, s[16:19], s25 offen offset:0 nt lds
    v_fma_f32 v48, v48, s28, -v19
    v_fma_f32 v49, v49, s28, -v19
    v_max3_f32 v22, v22, v47, v48
    v_fma_f32 v50, v50, s28, -v19
    v_mfma_f32_32x32x16_bf16 a[208:223], a[152:155], v[80:83], a[208:223]
    ds_read_b64_tr_b16 a[152:153], v16 offset:8192
    ds_read_b64_tr_b16 a[154:155], v16 offset:12288
    buffer_load_dwordx4 v5, s[16:19], s25 offen offset:1024 nt lds
    v_fma_f32 v51, v51, s28, -v19
    s_waitcnt lgkmcnt(6)
    v_mfma_f32_32x32x16_bf16 a[224:239], a[156:159], v[64:67], a[224:239]
    buffer_load_dwordx4 v4, s[16:19], s25 offen offset:2048 nt lds
    v_max3_f32 v22, v22, v49, v50
    v_fma_f32 v52, v52, s28, -v19
    v_fma_f32 v53, v53, s28, -v19
    v_max3_f32 v22, v22, v51, v52
    v_mfma_f32_32x32x16_bf16 a[240:255], a[156:159], v[80:83], a[240:255]
    ds_read_b64_tr_b16 a[156:157], v17 offset:8192
    ds_read_b64_tr_b16 a[158:159], v17 offset:12288
    buffer_load_dwordx4 v5, s[16:19], s25 offen offset:3072 nt lds
    v_fma_f32 v54, v54, s28, -v19
    s_waitcnt lgkmcnt(6)
    v_mfma_f32_32x32x16_bf16 v[96:111], a[144:147], v[72:75], v[96:111]
    s_add_u32 s25, s25, 0x4000
    s_add_u32 s51, s51, 0x4000
    s_and_b32 s51, s51, 0xffff
    v_fma_f32 v55, v55, s28, -v19
    v_max3_f32 v22, v22, v53, v54
    v_fma_f32 v56, v56, s28, -v19
    v_fma_f32 v57, v57, s28, -v19
    v_mfma_f32_32x32x16_bf16 v[112:127], a[144:147], v[88:91], v[112:127]
    ds_read_b64_tr_b16 a[144:145], v14 offset:8448
    ds_read_b64_tr_b16 a[146:147], v14 offset:12544
    s_add_u32 s37, s31, 0x2000
    s_cmp_eq_u32 s27, 5
    s_cselect_b32 s56, s8, s12
    s_cselect_b32 s57, s9, s13
    s_cselect_b32 s62, s35, 0
    s_cselect_b32 s63, s37, s24
    s_cselect_b32 s37, 0, 0x4000
    s_add_u32 m0, s26, s50
    v_max3_f32 v22, v22, v55, v56
    s_waitcnt lgkmcnt(6)
    v_mfma_f32_32x32x16_bf16 v[128:143], a[148:151], v[72:75], v[128:143]
    v_xor_b32 v31, s62, v0
    buffer_load_dwordx4 v31, s[56:59], s63 offen offset:0 nt lds
    v_fma_f32 v58, v58, s28, -v19
    v_fma_f32 v59, v59, s28, -v19
    v_max3_f32 v22, v22, v57, v58
    v_fma_f32 v60, v60, s28, -v19
    v_mfma_f32_32x32x16_bf16 v[144:159], a[148:151], v[88:91], v[144:159]
    ds_read_b64_tr_b16 a[148:149], v15 offset:8448
    ds_read_b64_tr_b16 a[150:151], v15 offset:12544
    v_xor_b32 v31, s62, v1
    buffer_load_dwordx4 v31, s[56:59], s63 offen offset:1024 nt lds
    v_fma_f32 v61, v61, s28, -v19
    s_waitcnt lgkmcnt(6)
    v_mfma_f32_32x32x16_bf16 v[160:175], a[152:155], v[72:75], v[160:175]
    v_xor_b32 v31, s62, v2
    buffer_load_dwordx4 v31, s[56:59], s63 offen offset:2048 nt lds
    v_max3_f32 v22, v22, v59, v60
    v_fma_f32 v62, v62, s28, -v19
    v_fma_f32 v63, v63, s28, -v19
    v_max3_f32 v22, v22, v61, v62
    v_mfma_f32_32x32x16_bf16 v[176:191], a[152:155], v[88:91], v[176:191]
    ds_read_b64_tr_b16 a[152:153], v16 offset:8448
    ds_read_b64_tr_b16 a[154:155], v16 offset:12544
    v_xor_b32 v31, s62, v3
    buffer_load_dwordx4 v31, s[56:59], s63 offen offset:3072 nt lds
    v_max3_f32 v22, v22, v63, v63
    s_waitcnt lgkmcnt(6)
    v_mfma_f32_32x32x16_bf16 v[192:207], a[156:159], v[72:75], v[192:207]
    s_add_u32 s24, s24, s37
    s_add_u32 s50, s50, 0x4000
    s_and_b32 s50, s50, 0xffff
    v_mfma_f32_32x32x16_bf16 v[208:223], a[156:159], v[88:91], v[208:223]
    ds_read_b64_tr_b16 a[156:157], v17 offset:8448
    ds_read_b64_tr_b16 a[158:159], v17 offset:12544
    s_waitcnt lgkmcnt(6)
    v_mfma_f32_32x32x16_bf16 v[224:239], a[144:147], v[72:75], v[224:239]
    v_mfma_f32_32x32x16_bf16 v[240:255], a[144:147], v[88:91], v[240:255]
    s_waitcnt lgkmcnt(4)
    v_mfma_f32_32x32x16_bf16 a[160:175], a[148:151], v[72:75], a[160:175]
    v_mfma_f32_32x32x16_bf16 a[176:191], a[148:151], v[88:91], a[176:191]
    s_waitcnt lgkmcnt(2)
    v_mfma_f32_32x32x16_bf16 a[192:207], a[152:155], v[72:75], a[192:207]
    ds_read_b128 a[128:131], v6 offset:0
    v_mfma_f32_32x32x16_bf16 a[208:223], a[152:155], v[88:91], a[208:223]
    ds_read_b128 a[132:135], v7 offset:0
    s_waitcnt lgkmcnt(2)
    v_mfma_f32_32x32x16_bf16 a[224:239], a[156:159], v[72:75], a[224:239]
    ds_read_b128 a[136:139], v8 offset:0
    v_mfma_f32_32x32x16_bf16 a[240:255], a[156:159], v[88:91], a[240:255]
    ds_read_b128 a[140:143], v9 offset:0
    v_cmp_lt_f32 vcc, 0x41000000, v22
    s_cbranch_vccz L_back_1
    s_call_b64 s[40:41], L_slow_0
L_back_1:
    s_waitcnt lgkmcnt(3)
    v_mfma_f32_32x32x16_bf16 v[64:79], a[128:131], a[0:3], 0
    s_add_u32 s33, s53, 0x4000
    s_and_b32 s33, s33, 0xffff
    s_sub_u32 s54, s33, s53
    s_mov_b32 s53, s33
    v_add_u32 v14, s54, v14
    v_mfma_f32_32x32x16_bf16 v[80:95], a[128:131], a[64:67], 0
    ds_read_b128 a[128:131], v10 offset:0
    v_add_u32 v15, s54, v15
    v_add_u32 v16, s54, v16
    v_add_u32 v17, s54, v17
    s_waitcnt lgkmcnt(3)
    v_mfma_f32_32x32x16_bf16 v[64:79], a[132:135], a[4:7], v[64:79]
    v_exp_f32 v32, v32
    v_exp_f32 v33, v33
    v_add_f32 v20, v20, v32
    v_mfma_f32_32x32x16_bf16 v[80:95], a[132:135], a[68:71], v[80:95]
    ds_read_b128 a[132:135], v11 offset:0
    v_add_f32 v20, v20, v33
    v_cvt_pk_bf16_f32 v32, v32, v33
    s_waitcnt lgkmcnt(3)
    v_mfma_f32_32x32x16_bf16 v[64:79], a[136:139], a[8:11], v[64:79]
    v_exp_f32 v34, v34
    v_exp_f32 v35, v35
    v_add_f32 v20, v20, v34
    v_add_f32 v20, v20, v35
    v_mfma_f32_32x32x16_bf16 v[80:95], a[136:139], a[72:75], v[80:95]
    ds_read_b128 a[136:139], v12 offset:0
    v_cvt_pk_bf16_f32 v33, v34, v35
    v_exp_f32 v36, v36
    s_waitcnt lgkmcnt(3)
    v_mfma_f32_32x32x16_bf16 v[64:79], a[140:143], a[12:15], v[64:79]
    v_exp_f32 v37, v37
    v_add_f32 v20, v20, v36
    v_add_f32 v20, v20, v37
    v_cvt_pk_bf16_f32 v34, v36, v37
    v_mfma_f32_32x32x16_bf16 v[80:95], a[140:143], a[76:79], v[80:95]
    ds_read_b128 a[140:143], v13 offset:0
    v_exp_f32 v38, v38
    s_waitcnt lgkmcnt(3)
    v_mfma_f32_32x32x16_bf16 v[64:79], a[128:131], a[16:19], v[64:79]
    v_exp_f32 v39, v39
    v_add_f32 v20, v20, v38
    v_add_f32 v20, v20, v39
    v_cvt_pk_bf16_f32 v35, v38, v39
    v_mfma_f32_32x32x16_bf16 v[80:95], a[128:131], a[80:83], v[80:95]
    ds_read_b128 a[128:131], v6 offset:256
    v_exp_f32 v48, v48
    v_exp_f32 v49, v49
    s_waitcnt lgkmcnt(3)
    v_mfma_f32_32x32x16_bf16 v[64:79], a[132:135], a[20:23], v[64:79]
    v_add_f32 v21, v21, v48
    v_add_f32 v21, v21, v49
    v_cvt_pk_bf16_f32 v48, v48, v49
    v_exp_f32 v50, v50
    v_mfma_f32_32x32x16_bf16 v[80:95], a[132:135], a[84:87], v[80:95]
    ds_read_b128 a[132:135], v7 offset:256
    v_exp_f32 v51, v51
    v_add_f32 v21, v21, v50
    s_waitcnt lgkmcnt(3)
    v_mfma_f32_32x32x16_bf16 v[64:79], a[136:139], a[24:27], v[64:79]
    v_add_f32 v21, v21, v51
    v_cvt_pk_bf16_f32 v49, v50, v51
    v_exp_f32 v52, v52
    v_mfma_f32_32x32x16_bf16 v[80:95], a[136:139], a[88:91], v[80:95]
    ds_read_b128 a[136:139], v8 offset:256
    v_exp_f32 v53, v53
    v_add_f32 v21, v21, v52
    v_add_f32 v21, v21, v53
    s_waitcnt lgkmcnt(3)
    v_mfma_f32_32x32x16_bf16 v[64:79], a[140:143], a[28:31], v[64:79]
    v_cvt_pk_bf16_f32 v50, v52, v53
    v_exp_f32 v54, v54
    v_exp_f32 v55, v55
    v_mfma_f32_32x32x16_bf16 v[80:95], a[140:143], a[92:95], v[80:95]
    ds_read_b128 a[140:143], v9 offset:256
    v_add_f32 v21, v21, v54
    v_add_f32 v21, v21, v55
    v_cvt_pk_bf16_f32 v51, v54, v55
    s_waitcnt lgkmcnt(3)
    v_mfma_f32_32x32x16_bf16 v[64:79], a[128:131], a[32:35], v[64:79]
    v_exp_f32 v40, v40
    v_exp_f32 v41, v41
    v_add_f32 v20, v20, v40
    v_mfma_f32_32x32x16_bf16 v[80:95], a[128:131], a[96:99], v[80:95]
    ds_read_b128 a[128:131], v10 offset:256
    v_add_f32 v20, v20, v41
    v_cvt_pk_bf16_f32 v40, v40, v41
    s_waitcnt lgkmcnt(3)
    v_mfma_f32_32x32x16_bf16 v[64:79], a[132:135], a[36:39], v[64:79]
    v_exp_f32 v42, v42
    v_exp_f32 v43, v43
    v_add_f32 v20, v20, v42
    v_add_f32 v20, v20, v43
    v_mfma_f32_32x32x16_bf16 v[80:95], a[132:135], a[100:103], v[80:95]
    ds_read_b128 a[132:135], v11 offset:256
    v_cvt_pk_bf16_f32 v41, v42, v43
    v_exp_f32 v44, v44
    s_waitcnt lgkmcnt(3)
    v_mfma_f32_32x32x16_bf16 v[64:79], a[136:139], a[40:43], v[64:79]
    v_exp_f32 v45, v45
    v_add_f32 v20, v20, v44
    v_add_f32 v20, v20, v45
    v_cvt_pk_bf16_f32 v42, v44, v45
    v_mfma_f32_32x32x16_bf16 v[80:95], a[136:139], a[104:107], v[80:95]
    ds_read_b128 a[136:139], v12 offset:256
    v_exp_f32 v46, v46
    s_waitcnt lgkmcnt(3)
    v_mfma_f32_32x32x16_bf16 v[64:79], a[140:143], a[44:47], v[64:79]
    v_exp_f32 v47, v47
    v_add_f32 v20, v20, v46
    v_add_f32 v20, v20, v47
    v_cvt_pk_bf16_f32 v43, v46, v47
    v_mfma_f32_32x32x16_bf16 v[80:95], a[140:143], a[108:111], v[80:95]
    ds_read_b128 a[140:143], v13 offset:256
    v_exp_f32 v56, v56
    v_exp_f32 v57, v57
    s_waitcnt lgkmcnt(3)
    v_mfma_f32_32x32x16_bf16 v[64:79], a[128:131], a[48:51], v[64:79]
    ds_read_b64_tr_b16 a[144:145], v14 offset:0
    v_add_f32 v21, v21, v56
    v_add_f32 v21, v21, v57
    v_cvt_pk_bf16_f32 v56, v56, v57
    v_mfma_f32_32x32x16_bf16 v[80:95], a[128:131], a[112:115], v[80:95]
    ds_read_b64_tr_b16 a[146:147], v14 offset:4096
    v_exp_f32 v58, v58
    v_exp_f32 v59, v59
    s_waitcnt lgkmcnt(4)
    v_mfma_f32_32x32x16_bf16 v[64:79], a[132:135], a[52:55], v[64:79]
    ds_read_b64_tr_b16 a[148:149], v15 offset:0
    v_add_f32 v21, v21, v58
    v_add_f32 v21, v21, v59
    v_cvt_pk_bf16_f32 v57, v58, v59
    v_mfma_f32_32x32x16_bf16 v[80:95], a[132:135], a[116:119], v[80:95]
    ds_read_b64_tr_b16 a[150:151], v15 offset:4096
    v_exp_f32 v60, v60
    v_exp_f32 v61, v61
    s_waitcnt lgkmcnt(5)
    v_mfma_f32_32x32x16_bf16 v[64:79], a[136:139], a[56:59], v[64:79]
    ds_read_b64_tr_b16 a[152:153], v16 offset:0
    v_add_f32 v21, v21, v60
    v_add_f32 v21, v21, v61
    v_cvt_pk_bf16_f32 v58, v60, v61
    v_mfma_f32_32x32x16_bf16 v[80:95], a[136:139], a[120:123], v[80:95]
    ds_read_b64_tr_b16 a[154:155], v16 offset:4096
    v_exp_f32 v62, v62
    v_exp_f32 v63, v63
    s_waitcnt lgkmcnt(6)
    v_mfma_f32_32x32x16_bf16 v[64:79], a[140:143], a[60:63], v[64:79]
    ds_read_b64_tr_b16 a[156:157], v17 offset:0
    v_add_f32 v21, v21, v62
    v_add_f32 v21, v21, v63
    v_cvt_pk_bf16_f32 v59, v62, v63
    v_mfma_f32_32x32x16_bf16 v[80:95], a[140:143], a[124:127], v[80:95]
    ds_read_b64_tr_b16 a[158:159], v17 offset:4096
    s_waitcnt lgkmcnt(6)
    v_mfma_f32_32x32x16_bf16 v[96:111], a[144:147], v[32:35], v[96:111]
    s_add_u32 s33, s52, 0x4000
    s_and_b32 s33, s33, 0xffff
    s_sub_u32 s54, s33, s52
    s_mov_b32 s52, s33
    v_add_u32 v6, s54, v6
    v_mfma_f32_32x32x16_bf16 v[112:127], a[144:147], v[48:51], v[112:127]
    ds_read_b64_tr_b16 a[144:145], v14 offset:256
    ds_read_b64_tr_b16 a[146:147], v14 offset:4352
    v_add_u32 v7, s54, v7
    v_add_u32 v8, s54, v8
    s_waitcnt lgkmcnt(6)
    v_mfma_f32_32x32x16_bf16 v[128:143], a[148:151], v[32:35], v[128:143]
    v_add_u32 v9, s54, v9
    v_add_u32 v10, s54, v10
    v_add_u32 v11, s54, v11
    v_add_u32 v12, s54, v12
    v_add_u32 v13, s54, v13
    v_mfma_f32_32x32x16_bf16 v[144:159], a[148:151], v[48:51], v[144:159]
    ds_read_b64_tr_b16 a[148:149], v15 offset:256
    ds_read_b64_tr_b16 a[150:151], v15 offset:4352
    s_waitcnt lgkmcnt(6)
    v_mfma_f32_32x32x16_bf16 v[160:175], a[152:155], v[32:35], v[160:175]
    v_mfma_f32_32x32x16_bf16 v[176:191], a[152:155], v[48:51], v[176:191]
    ds_read_b64_tr_b16 a[152:153], v16 offset:256
    ds_read_b64_tr_b16 a[154:155], v16 offset:4352
    s_waitcnt lgkmcnt(6)
    v_mfma_f32_32x32x16_bf16 v[192:207], a[156:159], v[32:35], v[192:207]
    v_fma_f32 v64, v64, s28, -v18
    v_fma_f32 v65, v65, s28, -v18
    v_fma_f32 v66, v66, s28, -v18
    v_fma_f32 v67, v67, s28, -v18
    v_max3_f32 v22, v64, v65, v66
    v_fma_f32 v68, v68, s28, -v18
    v_fma_f32 v69, v69, s28, -v18
    v_max3_f32 v22, v22, v67, v68
    v_fma_f32 v70, v70, s28, -v18
    v_fma_f32 v71, v71, s28, -v18
    v_mfma_f32_32x32x16_bf16 v[208:223], a[156:159], v[48:51], v[208:223]
    ds_read_b64_tr_b16 a[156:157], v17 offset:256
    ds_read_b64_tr_b16 a[158:159], v17 offset:4352
    v_max3_f32 v22, v22, v69, v70
    v_fma_f32 v72, v72, s28, -v18
    s_waitcnt lgkmcnt(6)
    v_mfma_f32_32x32x16_bf16 v[224:239], a[144:147], v[32:35], v[224:239]
    v_fma_f32 v73, v73, s28, -v18
    v_max3_f32 v22, v22, v71, v72
    v_fma_f32 v74, v74, s28, -v18
    v_fma_f32 v75, v75, s28, -v18
    v_max3_f32 v22, v22, v73, v74
    v_mfma_f32_32x32x16_bf16 v[240:255], a[144:147], v[48:51], v[240:255]
    ds_read_b64_tr_b16 a[144:145], v14 offset:8192
    ds_read_b64_tr_b16 a[146:147], v14 offset:12288
    v_fma_f32 v76, v76, s28, -v18
    v_fma_f32 v77, v77, s28, -v18
    s_waitcnt lgkmcnt(6)
    v_mfma_f32_32x32x16_bf16 a[160:175], a[148:151], v[32:35], a[160:175]
    s_waitcnt vmcnt(12)
    s_barrier
    v_max3_f32 v22, v22, v75, v76
    v_fma_f32 v78, v78, s28, -v18
    v_fma_f32 v79, v79, s28, -v18
    v_mfma_f32_32x32x16_bf16 a[176:191], a[148:151], v[48:51], a[176:191]
    ds_read_b64_tr_b16 a[148:149], v15 offset:8192
    ds_read_b64_tr_b16 a[150:151], v15 offset:12288
    s_add_u32 m0, s49, s51
    v_max3_f32 v22, v22, v77, v78
    s_waitcnt lgkmcnt(6)
    v_mfma_f32_32x32x16_bf16 a[192:207], a[152:155], v[32:35], a[192:207]
    buffer_load_dwordx4 v4, s[16:19], s25 offen offset:0 nt lds
    v_fma_f32 v80, v80, s28, -v19
    v_fma_f32 v81, v81, s28, -v19
    v_max3_f32 v22, v22, v79, v80
    v_fma_f32 v82, v82, s28, -v19
    v_mfma_f32_32x32x16_bf16 a[208:223], a[152:155], v[48:51], a[208:223]
    ds_read_b64_tr_b16 a[152:153], v16 offset:8192
    ds_read_b64_tr_b16 a[154:155], v16 offset:12288
    buffer_load_dwordx4 v5, s[16:19], s25 offen offset:1024 nt lds
    v_fma_f32 v83, v83, s28, -v19
    s_waitcnt lgkmcnt(6)
    v_mfma_f32_32x32x16_bf16 a[224:239], a[156:159], v[32:35], a[224:239]
    buffer_load_dwordx4 v4, s[16:19], s25 offen offset:2048 nt lds
    v_max3_f32 v22, v22, v81, v82
    v_fma_f32 v84, v84, s28, -v19
    v_fma_f32 v85, v85, s28, -v19
    v_max3_f32 v22, v22, v83, v84
    v_mfma_f32_32x32x16_bf16 a[240:255], a[156:159], v[48:51], a[240:255]
    ds_read_b64_tr_b16 a[156:157], v17 offset:8192
    ds_read_b64_tr_b16 a[158:159], v17 offset:12288
    buffer_load_dwordx4 v5, s[16:19], s25 offen offset:3072 nt lds
    v_fma_f32 v86, v86, s28, -v19
    s_waitcnt lgkmcnt(6)
    v_mfma_f32_32x32x16_bf16 v[96:111], a[144:147], v[40:43], v[96:111]
    s_add_u32 s25, s25, 0x4000
    s_add_u32 s51, s51, 0x4000
    s_and_b32 s51, s51, 0xffff
    v_fma_f32 v87, v87, s28, -v19
    v_max3_f32 v22, v22, v85, v86
    v_fma_f32 v88, v88, s28, -v19
    v_fma_f32 v89, v89, s28, -v19
    v_mfma_f32_32x32x16_bf16 v[112:127], a[144:147], v[56:59], v[112:127]
    ds_read_b64_tr_b16 a[144:145], v14 offset:8448
    ds_read_b64_tr_b16 a[146:147], v14 offset:12544
    s_add_u32 s37, s31, 0x3000
    s_cmp_eq_u32 s27, 5
    s_cselect_b32 s56, s8, s12
    s_cselect_b32 s57, s9, s13
    s_cselect_b32 s62, s36, 0
    s_cselect_b32 s63, s37, s24
    s_cselect_b32 s37, 0, 0x4000
    s_add_u32 m0, s26, s50
    v_max3_f32 v22, v22, v87, v88
    s_waitcnt lgkmcnt(6)
    v_mfma_f32_32x32x16_bf16 v[128:143], a[148:151], v[40:43], v[128:143]
    v_xor_b32 v31, s62, v0
    buffer_load_dwordx4 v31, s[56:59], s63 offen offset:0 nt lds
    v_fma_f32 v90, v90, s28, -v19
    v_fma_f32 v91, v91, s28, -v19
    v_max3_f32 v22, v22, v89, v90
    v_fma_f32 v92, v92, s28, -v19
    v_mfma_f32_32x32x16_bf16 v[144:159], a[148:151], v[56:59], v[144:159]
    ds_read_b64_tr_b16 a[148:149], v15 offset:8448
    ds_read_b64_tr_b16 a[150:151], v15 offset:12544
    v_xor_b32 v31, s62, v1
    buffer_load_dwordx4 v31, s[56:59], s63 offen offset:1024 nt lds
    v_fma_f32 v93, v93, s28, -v19
    s_waitcnt lgkmcnt(6)
    v_mfma_f32_32x32x16_bf16 v[160:175], a[152:155], v[40:43], v[160:175]
    v_xor_b32 v31, s62, v2
    buffer_load_dwordx4 v31, s[56:59], s63 offen offset:2048 nt lds
    v_max3_f32 v22, v22, v91, v92
    v_fma_f32 v94, v94, s28, -v19
    v_fma_f32 v95, v95, s28, -v19
    v_max3_f32 v22, v22, v93, v94
    v_mfma_f32_32x32x16_bf16 v[176:191], a[152:155], v[56:59], v[176:191]
    ds_read_b64_tr_b16 a[152:153], v16 offset:8448
    ds_read_b64_tr_b16 a[154:155], v16 offset:12544
    v_xor_b32 v31, s62, v3
    buffer_load_dwordx4 v31, s[56:59], s63 offen offset:3072 nt lds
    v_max3_f32 v22, v22, v95, v95
    s_waitcnt lgkmcnt(6)
    v_mfma_f32_32x32x16_bf16 v[192:207], a[156:159], v[40:43], v[192:207]
    s_add_u32 s24, s24, s37
    s_add_u32 s50, s50, 0x4000
    s_and_b32 s50, s50, 0xffff
    v_mfma_f32_32x32x16_bf16 v[208:223], a[156:159], v[56:59], v[208:223]
    ds_read_b64_tr_b16 a[156:157], v17 offset:8448
    ds_read_b64_tr_b16 a[158:159], v17 offset:12544
    s_waitcnt lgkmcnt(6)
    v_mfma_f32_32x32x16_bf16 v[224:239], a[144:147], v[40:43], v[224:239]
    v_mfma_f32_32x32x16_bf16 v[240:255], a[144:147], v[56:59], v[240:255]
    s_waitcnt lgkmcnt(4)
    v_mfma_f32_32x32x16_bf16 a[160:175], a[148:151], v[40:43], a[160:175]
    v_mfma_f32_32x32x16_bf16 a[176:191], a[148:151], v[56:59], a[176:191]
    s_waitcnt lgkmcnt(2)
    v_mfma_f32_32x32x16_bf16 a[192:207], a[152:155], v[40:43], a[192:207]
    ds_read_b128 a[128:131], v6 offset:0
    v_mfma_f32_32x32x16_bf16 a[208:223], a[152:155], v[56:59], a[208:223]
    ds_read_b128 a[132:135], v7 offset:0
    s_waitcnt lgkmcnt(2)
    v_mfma_f32_32x32x16_bf16 a[224:239], a[156:159], v[40:43], a[224:239]
    ds_read_b128 a[136:139], v8 offset:0
    v_mfma_f32_32x32x16_bf16 a[240:255], a[156:159], v[56:59], a[240:255]
    ds_read_b128 a[140:143], v9 offset:0
    v_cmp_lt_f32 vcc, 0x41000000, v22
    s_cbranch_vccz L_back_2
    s_call_b64 s[40:41], L_slow_1
L_back_2:
    s_add_u32 s27, s27, 1
    s_cmp_lt_u32 s27, 6
    s_cbranch_scc1 L_loop
    s_waitcnt lgkmcnt(3)
    v_mfma_f32_32x32x16_bf16 v[32:47], a[128:131], a[0:3], 0
    s_add_u32 s33, s53, 0x4000
    s_and_b32 s33, s33, 0xffff
    s_sub_u32 s54, s33, s53
    s_mov_b32 s53, s33
    v_add_u32 v14, s54, v14
    v_mfma_f32_32x32x16_bf16 v[48:63], a[128:131], a[64:67], 0
    ds_read_b128 a[128:131], v10 offset:0
    v_add_u32 v15, s54, v15
    v_add_u32 v16, s54, v16
    v_add_u32 v17, s54, v17
    s_waitcnt lgkmcnt(3)
    v_mfma_f32_32x32x16_bf16 v[32:47], a[132:135], a[4:7], v[32:47]
    v_exp_f32 v64, v64
    v_exp_f32 v65, v65
    v_add_f32 v20, v20, v64
    v_mfma_f32_32x32x16_bf16 v[48:63], a[132:135], a[68:71], v[48:63]
    ds_read_b128 a[132:135], v11 offset:0
    v_add_f32 v20, v20, v65
    v_cvt_pk_bf16_f32 v64, v64, v65
    s_waitcnt lgkmcnt(3)
    v_mfma_f32_32x32x16_bf16 v[32:47], a[136:139], a[8:11], v[32:47]
    v_exp_f32 v66, v66
    v_exp_f32 v67, v67
    v_add_f32 v20, v20, v66
    v_add_f32 v20, v20, v67
    v_mfma_f32_32x32x16_bf16 v[48:63], a[136:139], a[72:75], v[48:63]
    ds_read_b128 a[136:139], v12 offset:0
    v_cvt_pk_bf16_f32 v65, v66, v67
    v_exp_f32 v68, v68
    s_waitcnt lgkmcnt(3)
    v_mfma_f32_32x32x16_bf16 v[32:47], a[140:143], a[12:15], v[32:47]
    v_exp_f32 v69, v69
    v_add_f32 v20, v20, v68
    v_add_f32 v20, v20, v69
    v_cvt_pk_bf16_f32 v66, v68, v69
    v_mfma_f32_32x32x16_bf16 v[48:63], a[140:143], a[76:79], v[48:63]
    ds_read_b128 a[140:143], v13 offset:0
    v_exp_f32 v70, v70
    s_waitcnt lgkmcnt(3)
    v_mfma_f32_32x32x16_bf16 v[32:47], a[128:131], a[16:19], v[32:47]
    v_exp_f32 v71, v71
    v_add_f32 v20, v20, v70
    v_add_f32 v20, v20, v71
    v_cvt_pk_bf16_f32 v67, v70, v71
    v_mfma_f32_32x32x16_bf16 v[48:63], a[128:131], a[80:83], v[48:63]
    ds_read_b128 a[128:131], v6 offset:256
    v_exp_f32 v80, v80
    v_exp_f32 v81, v81
    s_waitcnt lgkmcnt(3)
    v_mfma_f32_32x32x16_bf16 v[32:47], a[132:135], a[20:23], v[32:47]
    v_add_f32 v21, v21, v80
    v_add_f32 v21, v21, v81
    v_cvt_pk_bf16_f32 v80, v80, v81
    v_exp_f32 v82, v82
    v_mfma_f32_32x32x16_bf16 v[48:63], a[132:135], a[84:87], v[48:63]
    ds_read_b128 a[132:135], v7 offset:256
    v_exp_f32 v83, v83
    v_add_f32 v21, v21, v82
    s_waitcnt lgkmcnt(3)
    v_mfma_f32_32x32x16_bf16 v[32:47], a[136:139], a[24:27], v[32:47]
    v_add_f32 v21, v21, v83
    v_cvt_pk_bf16_f32 v81, v82, v83
    v_exp_f32 v84, v84
    v_mfma_f32_32x32x16_bf16 v[48:63], a[136:139], a[88:91], v[48:63]
    ds_read_b128 a[136:139], v8 offset:256
    v_exp_f32 v85, v85
    v_add_f32 v21, v21, v84
    v_add_f32 v21, v21, v85
    s_waitcnt lgkmcnt(3)
    v_mfma_f32_32x32x16_bf16 v[32:47], a[140:143], a[28:31], v[32:47]
    v_cvt_pk_bf16_f32 v82, v84, v85
    v_exp_f32 v86, v86
    v_exp_f32 v87, v87
    v_mfma_f32_32x32x16_bf16 v[48:63], a[140:143], a[92:95], v[48:63]
    ds_read_b128 a[140:143], v9 offset:256
    v_add_f32 v21, v21, v86
    v_add_f32 v21, v21, v87
    v_cvt_pk_bf16_f32 v83, v86, v87
    s_waitcnt lgkmcnt(3)
    v_mfma_f32_32x32x16_bf16 v[32:47], a[128:131], a[32:35], v[32:47]
    v_exp_f32 v72, v72
    v_exp_f32 v73, v73
    v_add_f32 v20, v20, v72
    v_mfma_f32_32x32x16_bf16 v[48:63], a[128:131], a[96:99], v[48:63]
    ds_read_b128 a[128:131], v10 offset:256
    v_add_f32 v20, v20, v73
    v_cvt_pk_bf16_f32 v72, v72, v73
    s_waitcnt lgkmcnt(3)
    v_mfma_f32_32x32x16_bf16 v[32:47], a[132:135], a[36:39], v[32:47]
    v_exp_f32 v74, v74
    v_exp_f32 v75, v75
    v_add_f32 v20, v20, v74
    v_add_f32 v20, v20, v75
    v_mfma_f32_32x32x16_bf16 v[48:63], a[132:135], a[100:103], v[48:63]
    ds_read_b128 a[132:135], v11 offset:256
    v_cvt_pk_bf16_f32 v73, v74, v75
    v_exp_f32 v76, v76
    s_waitcnt lgkmcnt(3)
    v_mfma_f32_32x32x16_bf16 v[32:47], a[136:139], a[40:43], v[32:47]
    v_exp_f32 v77, v77
    v_add_f32 v20, v20, v76
    v_add_f32 v20, v20, v77
    v_cvt_pk_bf16_f32 v74, v76, v77
    v_mfma_f32_32x32x16_bf16 v[48:63], a[136:139], a[104:107], v[48:63]
    ds_read_b128 a[136:139], v12 offset:256
    v_exp_f32 v78, v78
    s_waitcnt lgkmcnt(3)
    v_mfma_f32_32x32x16_bf16 v[32:47], a[140:143], a[44:47], v[32:47]
    v_exp_f32 v79, v79
    v_add_f32 v20, v20, v78
    v_add_f32 v20, v20, v79
    v_cvt_pk_bf16_f32 v75, v78, v79
    v_mfma_f32_32x32x16_bf16 v[48:63], a[140:143], a[108:111], v[48:63]
    ds_read_b128 a[140:143], v13 offset:256
    v_exp_f32 v88, v88
    v_exp_f32 v89, v89
    s_waitcnt lgkmcnt(3)
    v_mfma_f32_32x32x16_bf16 v[32:47], a[128:131], a[48:51], v[32:47]
    ds_read_b64_tr_b16 a[144:145], v14 offset:0
    v_add_f32 v21, v21, v88
    v_add_f32 v21, v21, v89
    v_cvt_pk_bf16_f32 v88, v88, v89
    v_mfma_f32_32x32x16_bf16 v[48:63], a[128:131], a[112:115], v[48:63]
    ds_read_b64_tr_b16 a[146:147], v14 offset:4096
    v_exp_f32 v90, v90
    v_exp_f32 v91, v91
    s_waitcnt lgkmcnt(4)
    v_mfma_f32_32x32x16_bf16 v[32:47], a[132:135], a[52:55], v[32:47]
    ds_read_b64_tr_b16 a[148:149], v15 offset:0
    v_add_f32 v21, v21, v90
    v_add_f32 v21, v21, v91
    v_cvt_pk_bf16_f32 v89, v90, v91
    v_mfma_f32_32x32x16_bf16 v[48:63], a[132:135], a[116:119], v[48:63]
    ds_read_b64_tr_b16 a[150:151], v15 offset:4096
    v_exp_f32 v92, v92
    v_exp_f32 v93, v93
    s_waitcnt lgkmcnt(5)
    v_mfma_f32_32x32x16_bf16 v[32:47], a[136:139], a[56:59], v[32:47]
    ds_read_b64_tr_b16 a[152:153], v16 offset:0
    v_add_f32 v21, v21, v92
    v_add_f32 v21, v21, v93
    v_cvt_pk_bf16_f32 v90, v92, v93
    v_mfma_f32_32x32x16_bf16 v[48:63], a[136:139], a[120:123], v[48:63]
    ds_read_b64_tr_b16 a[154:155], v16 offset:4096
    v_exp_f32 v94, v94
    v_exp_f32 v95, v95
    s_waitcnt lgkmcnt(6)
    v_mfma_f32_32x32x16_bf16 v[32:47], a[140:143], a[60:63], v[32:47]
    ds_read_b64_tr_b16 a[156:157], v17 offset:0
    v_add_f32 v21, v21, v94
    v_add_f32 v21, v21, v95
    v_cvt_pk_bf16_f32 v91, v94, v95
    v_mfma_f32_32x32x16_bf16 v[48:63], a[140:143], a[124:127], v[48:63]
    ds_read_b64_tr_b16 a[158:159], v17 offset:4096
    s_waitcnt lgkmcnt(6)
    v_mfma_f32_32x32x16_bf16 v[96:111], a[144:147], v[64:67], v[96:111]
    s_sub_u32 s60, s50, 0x8000
    s_and_b32 s60, s60, 0xffff
    s_add_u32 s60, s60, s26
    s_sub_u32 s61, s50, 0x4000
    s_and_b32 s61, s61, 0xffff
    s_add_u32 s61, s61, s26
    s_add_u32 s33, s52, 0x4000
    s_and_b32 s33, s33, 0xffff
    s_sub_u32 s54, s33, s52
    s_mov_b32 s52, s33
    v_mfma_f32_32x32x16_bf16 v[112:127], a[144:147], v[80:83], v[112:127]
    ds_read_b64_tr_b16 a[144:145], v14 offset:256
    ds_read_b64_tr_b16 a[146:147], v14 offset:4352
    s_add_u32 s37, s31, 0x0
    s_add_u32 m0, s34, 0x0
    v_add_u32 v6, s54, v6
    s_waitcnt lgkmcnt(6)
    v_mfma_f32_32x32x16_bf16 v[128:143], a[148:151], v[64:67], v[128:143]
    v_xor_b32 v31, s35, v0
    buffer_load_dwordx4 v31, s[8:11], s37 offen offset:0 nt lds
    v_add_u32 v7, s54, v7
    v_add_u32 v8, s54, v8
    v_add_u32 v9, s54, v9
    v_add_u32 v10, s54, v10
    v_mfma_f32_32x32x16_bf16 v[144:159], a[148:151], v[80:83], v[144:159]
    ds_read_b64_tr_b16 a[148:149], v15 offset:256
    ds_read_b64_tr_b16 a[150:151], v15 offset:4352
    v_xor_b32 v31, s35, v1
    buffer_load_dwordx4 v31, s[8:11], s37 offen offset:1024 nt lds
    v_add_u32 v11, s54, v11
    s_waitcnt lgkmcnt(6)
    v_mfma_f32_32x32x16_bf16 v[160:175], a[152:155], v[64:67], v[160:175]
    v_xor_b32 v31, s35, v2
    buffer_load_dwordx4 v31, s[8:11], s37 offen offset:2048 nt lds
    v_add_u32 v12, s54, v12
    v_add_u32 v13, s54, v13
    v_mfma_f32_32x32x16_bf16 v[176:191], a[152:155], v[80:83], v[176:191]
    ds_read_b64_tr_b16 a[152:153], v16 offset:256
    ds_read_b64_tr_b16 a[154:155], v16 offset:4352
    v_xor_b32 v31, s35, v3
    buffer_load_dwordx4 v31, s[8:11], s37 offen offset:3072 nt lds
    s_waitcnt lgkmcnt(6)
    v_mfma_f32_32x32x16_bf16 v[192:207], a[156:159], v[64:67], v[192:207]
    s_add_u32 s37, s31, 0x1000
    s_add_u32 m0, s34, 0x1000
    v_fma_f32 v32, v32, s28, -v18
    v_fma_f32 v33, v33, s28, -v18
    v_fma_f32 v34, v34, s28, -v18
    v_fma_f32 v35, v35, s28, -v18
    v_max3_f32 v22, v32, v33, v34
    v_fma_f32 v36, v36, s28, -v18
    v_fma_f32 v37, v37, s28, -v18
    v_mfma_f32_32x32x16_bf16 v[208:223], a[156:159], v[80:83], v[208:223]
    ds_read_b64_tr_b16 a[156:157], v17 offset:256
    ds_read_b64_tr_b16 a[158:159], v17 offset:4352
    v_xor_b32 v31, s36, v0
    buffer_load_dwordx4 v31, s[8:11], s37 offen offset:0 nt lds
    v_max3_f32 v22, v22, v35, v36
    s_waitcnt lgkmcnt(6)
    v_mfma_f32_32x32x16_bf16 v[224:239], a[144:147], v[64:67], v[224:239]
    v_xor_b32 v31, s36, v1
    buffer_load_dwordx4 v31, s[8:11], s37 offen offset:1024 nt lds
    v_fma_f32 v38, v38, s28, -v18
    v_fma_f32 v39, v39, s28, -v18
    v_max3_f32 v22, v22, v37, v38
    v_fma_f32 v40, v40, s28, -v18
    v_mfma_f32_32x32x16_bf16 v[240:255], a[144:147], v[80:83], v[240:255]
    ds_read_b64_tr_b16 a[144:145], v14 offset:8192
    ds_read_b64_tr_b16 a[146:147], v14 offset:12288
    v_xor_b32 v31, s36, v2
    buffer_load_dwordx4 v31, s[8:11], s37 offen offset:2048 nt lds
    v_fma_f32 v41, v41, s28, -v18
    s_waitcnt lgkmcnt(6)
    v_mfma_f32_32x32x16_bf16 a[160:175], a[148:151], v[64:67], a[160:175]
    s_waitcnt vmcnt(19)
    s_barrier
    v_xor_b32 v31, s36, v3
    buffer_load_dwordx4 v31, s[8:11], s37 offen offset:3072 nt lds
    v_max3_f32 v22, v22, v39, v40
    v_fma_f32 v42, v42, s28, -v18
    v_mfma_f32_32x32x16_bf16 a[176:191], a[148:151], v[80:83], a[176:191]
    ds_read_b64_tr_b16 a[148:149], v15 offset:8192
    ds_read_b64_tr_b16 a[150:151], v15 offset:12288
    s_add_u32 s25, s25, 0x1fc0000
    v_fma_f32 v43, v43, s28, -v18
    s_waitcnt lgkmcnt(6)
    v_mfma_f32_32x32x16_bf16 a[192:207], a[152:155], v[64:67], a[192:207]
    s_add_u32 m0, s49, s51
    v_max3_f32 v22, v22, v41, v42
    v_fma_f32 v44, v44, s28, -v18
    v_fma_f32 v45, v45, s28, -v18
    v_max3_f32 v22, v22, v43, v44
    v_mfma_f32_32x32x16_bf16 a[208:223], a[152:155], v[80:83], a[208:223]
    ds_read_b64_tr_b16 a[152:153], v16 offset:8192
    ds_read_b64_tr_b16 a[154:155], v16 offset:12288
    buffer_load_dwordx4 v4, s[16:19], s25 offen offset:0 nt lds
    v_fma_f32 v46, v46, s28, -v18
    s_waitcnt lgkmcnt(6)
    v_mfma_f32_32x32x16_bf16 a[224:239], a[156:159], v[64:67], a[224:239]
    buffer_load_dwordx4 v5, s[16:19], s25 offen offset:1024 nt lds
    v_fma_f32 v47, v47, s28, -v18
    v_max3_f32 v22, v22, v45, v46
    v_fma_f32 v48, v48, s28, -v19
    v_fma_f32 v49, v49, s28, -v19
    v_mfma_f32_32x32x16_bf16 a[240:255], a[156:159], v[80:83], a[240:255]
    ds_read_b64_tr_b16 a[156:157], v17 offset:8192
    ds_read_b64_tr_b16 a[158:159], v17 offset:12288
    buffer_load_dwordx4 v4, s[16:19], s25 offen offset:2048 nt lds
    v_max3_f32 v22, v22, v47, v48
    s_waitcnt lgkmcnt(6)
    v_mfma_f32_32x32x16_bf16 v[96:111], a[144:147], v[72:75], v[96:111]
    buffer_load_dwordx4 v5, s[16:19], s25 offen offset:3072 nt lds
    v_fma_f32 v50, v50, s28, -v19
    v_fma_f32 v51, v51, s28, -v19
    v_max3_f32 v22, v22, v49, v50
    v_fma_f32 v52, v52, s28, -v19
    v_mfma_f32_32x32x16_bf16 v[112:127], a[144:147], v[88:91], v[112:127]
    ds_read_b64_tr_b16 a[144:145], v14 offset:8448
    ds_read_b64_tr_b16 a[146:147], v14 offset:12544
    s_add_u32 s25, s25, 0x4000
    s_add_u32 s51, s51, 0x4000
    s_and_b32 s51, s51, 0xffff
    v_fma_f32 v53, v53, s28, -v19
    s_waitcnt lgkmcnt(6)
    v_mfma_f32_32x32x16_bf16 v[128:143], a[148:151], v[72:75], v[128:143]
    s_add_u32 s24, s24, 0x1fc0000
    v_max3_f32 v22, v22, v51, v52
    v_fma_f32 v54, v54, s28, -v19
    v_fma_f32 v55, v55, s28, -v19
    v_max3_f32 v22, v22, v53, v54
    v_mfma_f32_32x32x16_bf16 v[144:159], a[148:151], v[88:91], v[144:159]
    ds_read_b64_tr_b16 a[148:149], v15 offset:8448
    ds_read_b64_tr_b16 a[150:151], v15 offset:12544
    s_add_u32 m0, s26, s50
    v_fma_f32 v56, v56, s28, -v19
    s_waitcnt lgkmcnt(6)
    v_mfma_f32_32x32x16_bf16 v[160:175], a[152:155], v[72:75], v[160:175]
    buffer_load_dwordx4 v0, s[12:15], s24 offen offset:0 nt lds
    v_fma_f32 v57, v57, s28, -v19
    v_max3_f32 v22, v22, v55, v56
    v_fma_f32 v58, v58, s28, -v19
    v_fma_f32 v59, v59, s28, -v19
    v_mfma_f32_32x32x16_bf16 v[176:191], a[152:155], v[88:91], v[176:191]
    ds_read_b64_tr_b16 a[152:153], v16 offset:8448
    ds_read_b64_tr_b16 a[154:155], v16 offset:12544
    buffer_load_dwordx4 v1, s[12:15], s24 offen offset:1024 nt lds
    v_max3_f32 v22, v22, v57, v58
    s_waitcnt lgkmcnt(6)
    v_mfma_f32_32x32x16_bf16 v[192:207], a[156:159], v[72:75], v[192:207]
    buffer_load_dwordx4 v2, s[12:15], s24 offen offset:2048 nt lds
    v_fma_f32 v60, v60, s28, -v19
    v_fma_f32 v61, v61, s28, -v19
    v_max3_f32 v22, v22, v59, v60
    v_fma_f32 v62, v62, s28, -v19
    v_mfma_f32_32x32x16_bf16 v[208:223], a[156:159], v[88:91], v[208:223]
    ds_read_b64_tr_b16 a[156:157], v17 offset:8448
    ds_read_b64_tr_b16 a[158:159], v17 offset:12544
    buffer_load_dwordx4 v3, s[12:15], s24 offen offset:3072 nt lds
    v_fma_f32 v63, v63, s28, -v19
    s_waitcnt lgkmcnt(6)
    v_mfma_f32_32x32x16_bf16 v[224:239], a[144:147], v[72:75], v[224:239]
    s_add_u32 s24, s24, 0x4000
    s_add_u32 s50, s50, 0x4000
    s_and_b32 s50, s50, 0xffff
    v_max3_f32 v22, v22, v61, v62
    v_max3_f32 v22, v22, v63, v63
    v_mfma_f32_32x32x16_bf16 v[240:255], a[144:147], v[88:91], v[240:255]
    s_waitcnt lgkmcnt(4)
    v_mfma_f32_32x32x16_bf16 a[160:175], a[148:151], v[72:75], a[160:175]
    v_mfma_f32_32x32x16_bf16 a[176:191], a[148:151], v[88:91], a[176:191]
    s_waitcnt lgkmcnt(2)
    v_mfma_f32_32x32x16_bf16 a[192:207], a[152:155], v[72:75], a[192:207]
    ds_read_b128 a[128:131], v6 offset:0
    v_mfma_f32_32x32x16_bf16 a[208:223], a[152:155], v[88:91], a[208:223]
    ds_read_b128 a[132:135], v7 offset:0
    s_waitcnt lgkmcnt(2)
    v_mfma_f32_32x32x16_bf16 a[224:239], a[156:159], v[72:75], a[224:239]
    ds_read_b128 a[136:139], v8 offset:0
    v_mfma_f32_32x32x16_bf16 a[240:255], a[156:159], v[88:91], a[240:255]
    ds_read_b128 a[140:143], v9 offset:0
    v_cmp_lt_f32 vcc, 0x41000000, v22
    s_cbranch_vccz L_back_3
    s_call_b64 s[40:41], L_slow_0
L_back_3:
    s_waitcnt lgkmcnt(3)
    v_mfma_f32_32x32x16_bf16 v[64:79], a[128:131], a[0:3], 0
    s_add_u32 s33, s53, 0x4000
    s_and_b32 s33, s33, 0xffff
    s_sub_u32 s54, s33, s53
    s_mov_b32 s53, s33
    v_add_u32 v14, s54, v14
    v_mfma_f32_32x32x16_bf16 v[80:95], a[128:131], a[64:67], 0
    ds_read_b128 a[128:131], v10 offset:0
    v_add_u32 v15, s54, v15
    v_add_u32 v16, s54, v16
    v_add_u32 v17, s54, v17
    s_waitcnt lgkmcnt(3)
    v_mfma_f32_32x32x16_bf16 v[64:79], a[132:135], a[4:7], v[64:79]
    v_exp_f32 v32, v32
    v_exp_f32 v33, v33
    v_add_f32 v20, v20, v32
    v_mfma_f32_32x32x16_bf16 v[80:95], a[132:135], a[68:71], v[80:95]
    ds_read_b128 a[132:135], v11 offset:0
    v_add_f32 v20, v20, v33
    v_cvt_pk_bf16_f32 v32, v32, v33
    s_waitcnt lgkmcnt(3)
    v_mfma_f32_32x32x16_bf16 v[64:79], a[136:139], a[8:11], v[64:79]
    v_exp_f32 v34, v34
    v_exp_f32 v35, v35
    v_add_f32 v20, v20, v34
    v_add_f32 v20, v20, v35
    v_mfma_f32_32x32x16_bf16 v[80:95], a[136:139], a[72:75], v[80:95]
    ds_read_b128 a[136:139], v12 offset:0
    v_cvt_pk_bf16_f32 v33, v34, v35
    v_exp_f32 v36, v36
    s_waitcnt lgkmcnt(3)
    v_mfma_f32_32x32x16_bf16 v[64:79], a[140:143], a[12:15], v[64:79]
    v_exp_f32 v37, v37
    v_add_f32 v20, v20, v36
    v_add_f32 v20, v20, v37
    v_cvt_pk_bf16_f32 v34, v36, v37
    v_mfma_f32_32x32x16_bf16 v[80:95], a[140:143], a[76:79], v[80:95]
    ds_read_b128 a[140:143], v13 offset:0
    v_exp_f32 v38, v38
    s_waitcnt lgkmcnt(3)
    v_mfma_f32_32x32x16_bf16 v[64:79], a[128:131], a[16:19], v[64:79]
    v_exp_f32 v39, v39
    v_add_f32 v20, v20, v38
    v_add_f32 v20, v20, v39
    v_cvt_pk_bf16_f32 v35, v38, v39
    v_mfma_f32_32x32x16_bf16 v[80:95], a[128:131], a[80:83], v[80:95]
    ds_read_b128 a[128:131], v6 offset:256
    v_exp_f32 v48, v48
    v_exp_f32 v49, v49
    s_waitcnt lgkmcnt(3)
    v_mfma_f32_32x32x16_bf16 v[64:79], a[132:135], a[20:23], v[64:79]
    v_add_f32 v21, v21, v48
    v_add_f32 v21, v21, v49
    v_cvt_pk_bf16_f32 v48, v48, v49
    v_exp_f32 v50, v50
    v_mfma_f32_32x32x16_bf16 v[80:95], a[132:135], a[84:87], v[80:95]
    ds_read_b128 a[132:135], v7 offset:256
    v_exp_f32 v51, v51
    v_add_f32 v21, v21, v50
    s_waitcnt lgkmcnt(3)
    v_mfma_f32_32x32x16_bf16 v[64:79], a[136:139], a[24:27], v[64:79]
    v_add_f32 v21, v21, v51
    v_cvt_pk_bf16_f32 v49, v50, v51
    v_exp_f32 v52, v52
    v_mfma_f32_32x32x16_bf16 v[80:95], a[136:139], a[88:91], v[80:95]
    ds_read_b128 a[136:139], v8 offset:256
    v_exp_f32 v53, v53
    v_add_f32 v21, v21, v52
    v_add_f32 v21, v21, v53
    s_waitcnt lgkmcnt(3)
    v_mfma_f32_32x32x16_bf16 v[64:79], a[140:143], a[28:31], v[64:79]
    v_cvt_pk_bf16_f32 v50, v52, v53
    v_exp_f32 v54, v54
    v_exp_f32 v55, v55
    v_mfma_f32_32x32x16_bf16 v[80:95], a[140:143], a[92:95], v[80:95]
    ds_read_b128 a[140:143], v9 offset:256
    v_add_f32 v21, v21, v54
    v_add_f32 v21, v21, v55
    v_cvt_pk_bf16_f32 v51, v54, v55
    s_waitcnt lgkmcnt(3)
    v_mfma_f32_32x32x16_bf16 v[64:79], a[128:131], a[32:35], v[64:79]
    v_exp_f32 v40, v40
    v_exp_f32 v41, v41
    v_add_f32 v20, v20, v40
    v_mfma_f32_32x32x16_bf16 v[80:95], a[128:131], a[96:99], v[80:95]
    ds_read_b128 a[128:131], v10 offset:256
    v_add_f32 v20, v20, v41
    v_cvt_pk_bf16_f32 v40, v40, v41
    s_waitcnt lgkmcnt(3)
    v_mfma_f32_32x32x16_bf16 v[64:79], a[132:135], a[36:39], v[64:79]
    v_exp_f32 v42, v42
    v_exp_f32 v43, v43
    v_add_f32 v20, v20, v42
    v_add_f32 v20, v20, v43
    v_mfma_f32_32x32x16_bf16 v[80:95], a[132:135], a[100:103], v[80:95]
    ds_read_b128 a[132:135], v11 offset:256
    v_cvt_pk_bf16_f32 v41, v42, v43
    v_exp_f32 v44, v44
    s_waitcnt lgkmcnt(3)
    v_mfma_f32_32x32x16_bf16 v[64:79], a[136:139], a[40:43], v[64:79]
    v_exp_f32 v45, v45
    v_add_f32 v20, v20, v44
    v_add_f32 v20, v20, v45
    v_cvt_pk_bf16_f32 v42, v44, v45
    v_mfma_f32_32x32x16_bf16 v[80:95], a[136:139], a[104:107], v[80:95]
    ds_read_b128 a[136:139], v12 offset:256
    v_exp_f32 v46, v46
    s_waitcnt lgkmcnt(3)
    v_mfma_f32_32x32x16_bf16 v[64:79], a[140:143], a[44:47], v[64:79]
    v_exp_f32 v47, v47
    v_add_f32 v20, v20, v46
    v_add_f32 v20, v20, v47
    v_cvt_pk_bf16_f32 v43, v46, v47
    v_mfma_f32_32x32x16_bf16 v[80:95], a[140:143], a[108:111], v[80:95]
    ds_read_b128 a[140:143], v13 offset:256
    v_exp_f32 v56, v56
    v_exp_f32 v57, v57
    s_waitcnt lgkmcnt(3)
    v_mfma_f32_32x32x16_bf16 v[64:79], a[128:131], a[48:51], v[64:79]
    ds_read_b64_tr_b16 a[144:145], v14 offset:0
    v_add_f32 v21, v21, v56
    v_add_f32 v21, v21, v57
    v_cvt_pk_bf16_f32 v56, v56, v57
    v_mfma_f32_32x32x16_bf16 v[80:95], a[128:131], a[112:115], v[80:95]
    ds_read_b64_tr_b16 a[146:147], v14 offset:4096
    v_exp_f32 v58, v58
    v_exp_f32 v59, v59
    s_waitcnt lgkmcnt(4)
    v_mfma_f32_32x32x16_bf16 v[64:79], a[132:135], a[52:55], v[64:79]
    ds_read_b64_tr_b16 a[148:149], v15 offset:0
    v_add_f32 v21, v21, v58
    v_add_f32 v21, v21, v59
    v_cvt_pk_bf16_f32 v57, v58, v59
    v_mfma_f32_32x32x16_bf16 v[80:95], a[132:135], a[116:119], v[80:95]
    ds_read_b64_tr_b16 a[150:151], v15 offset:4096
    v_exp_f32 v60, v60
    v_exp_f32 v61, v61
    s_waitcnt lgkmcnt(5)
    v_mfma_f32_32x32x16_bf16 v[64:79], a[136:139], a[56:59], v[64:79]
    ds_read_b64_tr_b16 a[152:153], v16 offset:0
    v_add_f32 v21, v21, v60
    v_add_f32 v21, v21, v61
    v_cvt_pk_bf16_f32 v58, v60, v61
    v_mfma_f32_32x32x16_bf16 v[80:95], a[136:139], a[120:123], v[80:95]
    ds_read_b64_tr_b16 a[154:155], v16 offset:4096
    v_exp_f32 v62, v62
    v_exp_f32 v63, v63
    s_waitcnt lgkmcnt(6)
    v_mfma_f32_32x32x16_bf16 v[64:79], a[140:143], a[60:63], v[64:79]
    ds_read_b64_tr_b16 a[156:157], v17 offset:0
    v_add_f32 v21, v21, v62
    v_add_f32 v21, v21, v63
    v_cvt_pk_bf16_f32 v59, v62, v63
    v_mfma_f32_32x32x16_bf16 v[80:95], a[140:143], a[124:127], v[80:95]
    ds_read_b64_tr_b16 a[158:159], v17 offset:4096
    s_waitcnt lgkmcnt(6)
    v_mfma_f32_32x32x16_bf16 v[96:111], a[144:147], v[32:35], v[96:111]
    s_waitcnt vmcnt(8)
    v_mbcnt_lo_u32_b32 v29, -1, 0
    v_mbcnt_hi_u32_b32 v29, -1, v29
    v_bfe_u32 v29, v29, 3, 2
    s_add_u32 s32, s34, 0x0
    s_sub_u32 s32, s32, s52
    v_mov_b32 v30, s32
    s_add_u32 s32, s34, 0x0
    s_sub_u32 s32, s32, s52
    v_cmp_eq_u32 vcc, 1, v29
    v_mov_b32 v28, s32
    s_nop 0
    v_cndmask_b32 v30, v30, v28, vcc
    s_add_u32 s32, s60, 0xffffe000
    s_sub_u32 s32, s32, s52
    v_cmp_eq_u32 vcc, 2, v29
    v_mov_b32 v28, s32
    s_nop 0
    v_cndmask_b32 v30, v30, v28, vcc
    s_add_u32 s32, s61, 0xffffd000
    s_sub_u32 s32, s32, s52
    v_cmp_eq_u32 vcc, 3, v29
    v_mov_b32 v28, s32
    s_nop 0
    v_cndmask_b32 v30, v30, v28, vcc
    v_mfma_f32_32x32x16_bf16 v[112:127], a[144:147], v[48:51], v[112:127]
    ds_read_b64_tr_b16 a[144:145], v14 offset:256
    ds_read_b64_tr_b16 a[146:147], v14 offset:4352
    s_waitcnt lgkmcnt(6)
    v_mfma_f32_32x32x16_bf16 v[128:143], a[148:151], v[32:35], v[128:143]
    v_mfma_f32_32x32x16_bf16 v[144:159], a[148:151], v[48:51], v[144:159]
    ds_read_b64_tr_b16 a[148:149], v15 offset:256
    ds_read_b64_tr_b16 a[150:151], v15 offset:4352
    s_waitcnt lgkmcnt(6)
    v_mfma_f32_32x32x16_bf16 v[160:175], a[152:155], v[32:35], v[160:175]
    v_add_u32 v29, v6, v30
    ds_read_b128 a[0:3], v29 offset:0
    v_mfma_f32_32x32x16_bf16 v[176:191], a[152:155], v[48:51], v[176:191]
    ds_read_b64_tr_b16 a[152:153], v16 offset:256
    ds_read_b64_tr_b16 a[154:155], v16 offset:4352
    v_add_u32 v29, v7, v30
    ds_read_b128 a[4:7], v29 offset:0
    s_waitcnt lgkmcnt(8)
    v_mfma_f32_32x32x16_bf16 v[192:207], a[156:159], v[32:35], v[192:207]
    v_add_u32 v29, v8, v30
    ds_read_b128 a[8:11], v29 offset:0
    v_add_u32 v29, v9, v30
    ds_read_b128 a[12:15], v29 offset:0
    v_fma_f32 v64, v64, s28, -v18
    v_mfma_f32_32x32x16_bf16 v[208:223], a[156:159], v[48:51], v[208:223]
    ds_read_b64_tr_b16 a[156:157], v17 offset:256
    ds_read_b64_tr_b16 a[158:159], v17 offset:4352
    v_add_u32 v29, v10, v30
    ds_read_b128 a[16:19], v29 offset:0
    s_waitcnt lgkmcnt(11)
    v_mfma_f32_32x32x16_bf16 v[224:239], a[144:147], v[32:35], v[224:239]
    v_add_u32 v29, v11, v30
    ds_read_b128 a[20:23], v29 offset:0
    v_add_u32 v29, v12, v30
    ds_read_b128 a[24:27], v29 offset:0
    v_fma_f32 v65, v65, s28, -v18
    v_mfma_f32_32x32x16_bf16 v[240:255], a[144:147], v[48:51], v[240:255]
    ds_read_b64_tr_b16 a[144:145], v14 offset:8192
    ds_read_b64_tr_b16 a[146:147], v14 offset:12288
    v_add_u32 v29, v13, v30
    ds_read_b128 a[28:31], v29 offset:0
    s_waitcnt lgkmcnt(14)
    v_mfma_f32_32x32x16_bf16 a[160:175], a[148:151], v[32:35], a[160:175]
    v_add_u32 v29, v6, v30
    ds_read_b128 a[32:35], v29 offset:256
    v_add_u32 v29, v7, v30
    ds_read_b128 a[36:39], v29 offset:256
    v_add_u32 v29, v8, v30
    ds_read_b128 a[40:43], v29 offset:256
    v_add_u32 v29, v9, v30
    ds_read_b128 a[44:47], v29 offset:256
    v_add_u32 v29, v10, v30
    ds_read_b128 a[48:51], v29 offset:256
    v_add_u32 v29, v11, v30
    ds_read_b128 a[52:55], v29 offset:256
    v_add_u32 v29, v12, v30
    ds_read_b128 a[56:59], v29 offset:256
    v_add_u32 v29, v13, v30
    ds_read_b128 a[60:63], v29 offset:256
    s_waitcnt vmcnt(8)
    s_barrier
    v_fma_f32 v66, v66, s28, -v18
    v_fma_f32 v67, v67, s28, -v18
    v_max3_f32 v22, v64, v65, v66
    v_mfma_f32_32x32x16_bf16 a[176:191], a[148:151], v[48:51], a[176:191]
    ds_read_b64_tr_b16 a[148:149], v15 offset:8192
    ds_read_b64_tr_b16 a[150:151], v15 offset:12288
    s_waitcnt lgkmcnt(2)
    v_fma_f32 v68, v68, s28, -v18
    s_waitcnt lgkmcnt(2)
    v_mfma_f32_32x32x16_bf16 a[192:207], a[152:155], v[32:35], a[192:207]
    s_add_u32 s37, s31, 0x4000
    s_add_u32 m0, s34, 0x0
    v_fma_f32 v69, v69, s28, -v18
    v_max3_f32 v22, v22, v67, v68
    v_fma_f32 v70, v70, s28, -v18
    v_fma_f32 v71, v71, s28, -v18
    v_mfma_f32_32x32x16_bf16 a[208:223], a[152:155], v[48:51], a[208:223]
    ds_read_b64_tr_b16 a[152:153], v16 offset:8192
    ds_read_b64_tr_b16 a[154:155], v16 offset:12288
    v_xor_b32 v31, s35, v0
    buffer_load_dwordx4 v31, s[8:11], s37 offen offset:0 nt lds
    v_max3_f32 v22, v22, v69, v70
    s_waitcnt lgkmcnt(4)
    v_mfma_f32_32x32x16_bf16 a[224:239], a[156:159], v[32:35], a[224:239]
    v_xor_b32 v31, s35, v1
    buffer_load_dwordx4 v31, s[8:11], s37 offen offset:1024 nt lds
    v_fma_f32 v72, v72, s28, -v18
    v_fma_f32 v73, v73, s28, -v18
    v_max3_f32 v22, v22, v71, v72
    v_fma_f32 v74, v74, s28, -v18
    v_mfma_f32_32x32x16_bf16 a[240:255], a[156:159], v[48:51], a[240:255]
    ds_read_b64_tr_b16 a[156:157], v17 offset:8192
    ds_read_b64_tr_b16 a[158:159], v17 offset:12288
    v_xor_b32 v31, s35, v2
    buffer_load_dwordx4 v31, s[8:11], s37 offen offset:2048 nt lds
    v_fma_f32 v75, v75, s28, -v18
    s_waitcnt lgkmcnt(6)
    v_mfma_f32_32x32x16_bf16 v[96:111], a[144:147], v[40:43], v[96:111]
    v_xor_b32 v31, s35, v3
    buffer_load_dwordx4 v31, s[8:11], s37 offen offset:3072 nt lds
    v_max3_f32 v22, v22, v73, v74
    v_fma_f32 v76, v76, s28, -v18
    v_fma_f32 v77, v77, s28, -v18
    v_max3_f32 v22, v22, v75, v76
    v_mfma_f32_32x32x16_bf16 v[112:127], a[144:147], v[56:59], v[112:127]
    ds_read_b64_tr_b16 a[144:145], v14 offset:8448
    ds_read_b64_tr_b16 a[146:147], v14 offset:12544
    s_add_u32 s37, s31, 0x5000
    s_add_u32 m0, s34, 0x1000
    v_fma_f32 v78, v78, s28, -v18
    s_waitcnt lgkmcnt(6)
    v_mfma_f32_32x32x16_bf16 v[128:143], a[148:151], v[40:43], v[128:143]
    v_xor_b32 v31, s36, v0
    buffer_load_dwordx4 v31, s[8:11], s37 offen offset:0 nt lds
    v_fma_f32 v79, v79, s28, -v18
    v_max3_f32 v22, v22, v77, v78
    v_fma_f32 v80, v80, s28, -v19
    v_fma_f32 v81, v81, s28, -v19
    v_mfma_f32_32x32x16_bf16 v[144:159], a[148:151], v[56:59], v[144:159]
    ds_read_b64_tr_b16 a[148:149], v15 offset:8448
    ds_read_b64_tr_b16 a[150:151], v15 offset:12544
    v_xor_b32 v31, s36, v1
    buffer_load_dwordx4 v31, s[8:11], s37 offen offset:1024 nt lds
    v_max3_f32 v22, v22, v79, v80
    s_waitcnt lgkmcnt(6)
    v_mfma_f32_32x32x16_bf16 v[160:175], a[152:155], v[40:43], v[160:175]
    v_xor_b32 v31, s36, v2
    buffer_load_dwordx4 v31, s[8:11], s37 offen offset:2048 nt lds
    v_fma_f32 v82, v82, s28, -v19
    v_fma_f32 v83, v83, s28, -v19
    v_max3_f32 v22, v22, v81, v82
    v_fma_f32 v84, v84, s28, -v19
    v_mfma_f32_32x32x16_bf16 v[176:191], a[152:155], v[56:59], v[176:191]
    ds_read_b64_tr_b16 a[152:153], v16 offset:8448
    ds_read_b64_tr_b16 a[154:155], v16 offset:12544
    v_xor_b32 v31, s36, v3
    buffer_load_dwordx4 v31, s[8:11], s37 offen offset:3072 nt lds
    v_fma_f32 v85, v85, s28, -v19
    s_waitcnt lgkmcnt(6)
    v_mfma_f32_32x32x16_bf16 v[192:207], a[156:159], v[40:43], v[192:207]
    s_add_u32 s37, s31, 0x6000
    s_mov_b32 m0, s60
    v_max3_f32 v22, v22, v83, v84
    v_fma_f32 v86, v86, s28, -v19
    v_fma_f32 v87, v87, s28, -v19
    v_max3_f32 v22, v22, v85, v86
    v_mfma_f32_32x32x16_bf16 v[208:223], a[156:159], v[56:59], v[208:223]
    ds_read_b64_tr_b16 a[156:157], v17 offset:8448
    ds_read_b64_tr_b16 a[158:159], v17 offset:12544
    v_xor_b32 v31, s35, v0
    buffer_load_dwordx4 v31, s[8:11], s37 offen offset:0 nt lds
    v_fma_f32 v88, v88, s28, -v19
    s_waitcnt lgkmcnt(6)
    v_mfma_f32_32x32x16_bf16 v[224:239], a[144:147], v[40:43], v[224:239]
    v_xor_b32 v31, s35, v1
    buffer_load_dwordx4 v31, s[8:11], s37 offen offset:1024 nt lds
    v_fma_f32 v89, v89, s28, -v19
    v_max3_f32 v22, v22, v87, v88
    v_fma_f32 v90, v90, s28, -v19
    v_fma_f32 v91, v91, s28, -v19
    v_mfma_f32_32x32x16_bf16 v[240:255], a[144:147], v[56:59], v[240:255]
    v_xor_b32 v31, s35, v2
    buffer_load_dwordx4 v31, s[8:11], s37 offen offset:2048 nt lds
    v_max3_f32 v22, v22, v89, v90
    v_fma_f32 v92, v92, s28, -v19
    v_fma_f32 v93, v93, s28, -v19
    s_waitcnt lgkmcnt(4)
    v_mfma_f32_32x32x16_bf16 a[160:175], a[148:151], v[40:43], a[160:175]
    v_xor_b32 v31, s35, v3
    buffer_load_dwordx4 v31, s[8:11], s37 offen offset:3072 nt lds
    v_max3_f32 v22, v22, v91, v92
    v_fma_f32 v94, v94, s28, -v19
    v_fma_f32 v95, v95, s28, -v19
    v_max3_f32 v22, v22, v93, v94
    v_mfma_f32_32x32x16_bf16 a[176:191], a[148:151], v[56:59], a[176:191]
    s_add_u32 s37, s31, 0x7000
    s_mov_b32 m0, s61
    v_max3_f32 v22, v22, v95, v95
    s_waitcnt lgkmcnt(2)
    v_mfma_f32_32x32x16_bf16 a[192:207], a[152:155], v[40:43], a[192:207]
    v_xor_b32 v31, s36, v0
    buffer_load_dwordx4 v31, s[8:11], s37 offen offset:0 nt lds
    v_mfma_f32_32x32x16_bf16 a[208:223], a[152:155], v[56:59], a[208:223]
    v_xor_b32 v31, s36, v1
    buffer_load_dwordx4 v31, s[8:11], s37 offen offset:1024 nt lds
    s_waitcnt lgkmcnt(0)
    v_mfma_f32_32x32x16_bf16 a[224:239], a[156:159], v[40:43], a[224:239]
    v_xor_b32 v31, s36, v2
    buffer_load_dwordx4 v31, s[8:11], s37 offen offset:2048 nt lds
    v_mfma_f32_32x32x16_bf16 a[240:255], a[156:159], v[56:59], a[240:255]
    v_xor_b32 v31, s36, v3
    buffer_load_dwordx4 v31, s[8:11], s37 offen offset:3072 nt lds
    v_cmp_lt_f32 vcc, 0x41000000, v22
    s_cbranch_vccz L_back_4
    s_call_b64 s[40:41], L_slow_1
L_back_4:
    s_cmp_eq_u32 s55, 1
    s_cbranch_scc1 L_last
    s_add_u32 s33, s53, 0x4000
    s_and_b32 s33, s33, 0xffff
    s_sub_u32 s54, s33, s53
    s_mov_b32 s53, s33
    v_add_u32 v14, s54, v14
    v_add_u32 v15, s54, v15
    v_add_u32 v16, s54, v16
    v_add_u32 v17, s54, v17
    ds_read_b64_tr_b16 a[144:145], v14 offset:0
    ds_read_b64_tr_b16 a[146:147], v14 offset:4096
    ds_read_b64_tr_b16 a[148:149], v14 offset:8192
    ds_read_b64_tr_b16 a[150:151], v14 offset:12288
    ds_read_b64_tr_b16 a[152:153], v15 offset:0
    ds_read_b64_tr_b16 a[154:155], v15 offset:4096
    ds_read_b64_tr_b16 a[156:157], v15 offset:8192
    ds_read_b64_tr_b16 a[158:159], v15 offset:12288
    v_exp_f32 v64, v64
    v_exp_f32 v65, v65
    v_add_f32 v20, v20, v64
    v_add_f32 v20, v20, v65
    v_cvt_pk_bf16_f32 v64, v64, v65
    v_exp_f32 v66, v66
    s_add_u32 m0, s49, s51
    v_exp_f32 v67, v67
    v_add_f32 v20, v20, v66
    v_add_f32 v20, v20, v67
    v_cvt_pk_bf16_f32 v65, v66, v67
    v_exp_f32 v68, v68
    v_exp_f32 v69, v69
    buffer_load_dwordx4 v4, s[16:19], s25 offen offset:0 nt lds
    v_add_f32 v20, v20, v68
    v_add_f32 v20, v20, v69
    v_cvt_pk_bf16_f32 v66, v68, v69
    v_exp_f32 v70, v70
    v_exp_f32 v71, v71
    v_add_f32 v20, v20, v70
    buffer_load_dwordx4 v5, s[16:19], s25 offen offset:1024 nt lds
    v_add_f32 v20, v20, v71
    v_cvt_pk_bf16_f32 v67, v70, v71
    v_exp_f32 v80, v80
    v_exp_f32 v81, v81
    v_add_f32 v21, v21, v80
    v_add_f32 v21, v21, v81
    buffer_load_dwordx4 v4, s[16:19], s25 offen offset:2048 nt lds
    v_cvt_pk_bf16_f32 v80, v80, v81
    v_exp_f32 v82, v82
    v_exp_f32 v83, v83
    v_add_f32 v21, v21, v82
    v_add_f32 v21, v21, v83
    v_cvt_pk_bf16_f32 v81, v82, v83
    buffer_load_dwordx4 v5, s[16:19], s25 offen offset:3072 nt lds
    v_exp_f32 v84, v84
    v_exp_f32 v85, v85
    v_add_f32 v21, v21, v84
    v_add_f32 v21, v21, v85
    v_cvt_pk_bf16_f32 v82, v84, v85
    v_exp_f32 v86, v86
    s_add_u32 s25, s25, 0x4000
    s_add_u32 s51, s51, 0x4000
    s_and_b32 s51, s51, 0xffff
    v_exp_f32 v87, v87
    v_add_f32 v21, v21, v86
    v_add_f32 v21, v21, v87
    v_cvt_pk_bf16_f32 v83, v86, v87
    v_exp_f32 v72, v72
    v_exp_f32 v73, v73
    s_add_u32 m0, s26, s50
    v_add_f32 v20, v20, v72
    v_add_f32 v20, v20, v73
    v_cvt_pk_bf16_f32 v72, v72, v73
    v_exp_f32 v74, v74
    v_exp_f32 v75, v75
    v_add_f32 v20, v20, v74
    buffer_load_dwordx4 v0, s[12:15], s24 offen offset:0 nt lds
    v_add_f32 v20, v20, v75
    v_cvt_pk_bf16_f32 v73, v74, v75
    v_exp_f32 v76, v76
    v_exp_f32 v77, v77
    v_add_f32 v20, v20, v76
    v_add_f32 v20, v20, v77
    buffer_load_dwordx4 v1, s[12:15], s24 offen offset:1024 nt lds
    v_cvt_pk_bf16_f32 v74, v76, v77
    v_exp_f32 v78, v78
    v_exp_f32 v79, v79
    v_add_f32 v20, v20, v78
    v_add_f32 v20, v20, v79
    v_cvt_pk_bf16_f32 v75, v78, v79
    buffer_load_dwordx4 v2, s[12:15], s24 offen offset:2048 nt lds
    v_exp_f32 v88, v88
    v_exp_f32 v89, v89
    v_add_f32 v21, v21, v88
    v_add_f32 v21, v21, v89
    v_cvt_pk_bf16_f32 v88, v88, v89
    v_exp_f32 v90, v90
    buffer_load_dwordx4 v3, s[12:15], s24 offen offset:3072 nt lds
    v_exp_f32 v91, v91
    v_add_f32 v21, v21, v90
    v_add_f32 v21, v21, v91
    v_cvt_pk_bf16_f32 v89, v90, v91
    v_exp_f32 v92, v92
    v_exp_f32 v93, v93
    s_add_u32 s24, s24, 0x4000
    s_add_u32 s50, s50, 0x4000
    s_and_b32 s50, s50, 0xffff
    v_add_f32 v21, v21, v92
    v_add_f32 v21, v21, v93
    v_cvt_pk_bf16_f32 v90, v92, v93
    v_exp_f32 v94, v94
    v_exp_f32 v95, v95
    v_add_f32 v21, v21, v94
    v_add_f32 v21, v21, v95
    v_cvt_pk_bf16_f32 v91, v94, v95
    s_nop 1
    s_waitcnt lgkmcnt(6)
    v_mfma_f32_32x32x16_bf16 v[96:111], a[144:147], v[64:67], v[96:111]
    s_add_u32 s33, s52, 0xc000
    s_and_b32 s33, s33, 0xffff
    s_sub_u32 s54, s33, s52
    s_mov_b32 s52, s33
    v_add_u32 v6, s54, v6
    v_mfma_f32_32x32x16_bf16 v[112:127], a[144:147], v[80:83], v[112:127]
    ds_read_b64_tr_b16 a[144:145], v16 offset:0
    ds_read_b64_tr_b16 a[146:147], v16 offset:4096
    v_add_u32 v7, s54, v7
    v_add_u32 v8, s54, v8
    s_waitcnt lgkmcnt(6)
    v_mfma_f32_32x32x16_bf16 v[96:111], a[148:151], v[72:75], v[96:111]
    v_add_u32 v9, s54, v9
    v_add_u32 v10, s54, v10
    v_add_u32 v11, s54, v11
    v_add_u32 v12, s54, v12
    v_add_u32 v13, s54, v13
    v_mfma_f32_32x32x16_bf16 v[112:127], a[148:151], v[88:91], v[112:127]
    ds_read_b64_tr_b16 a[148:149], v16 offset:8192
    ds_read_b64_tr_b16 a[150:151], v16 offset:12288
    v_mov_b32 v27, v20
    s_nop 1
    v_permlane32_swap_b32 v20, v27
    s_nop 1
    v_add_f32 v27, v27, v20
    v_rcp_f32 v24, v27
    v_mov_b32 v27, v21
    s_nop 1
    v_permlane32_swap_b32 v21, v27
    s_nop 1
    v_add_f32 v27, v27, v21
    v_rcp_f32 v25, v27
    s_waitcnt lgkmcnt(6)
    v_mfma_f32_32x32x16_bf16 v[128:143], a[152:155], v[64:67], v[128:143]
    v_mfma_f32_32x32x16_bf16 v[144:159], a[152:155], v[80:83], v[144:159]
    ds_read_b64_tr_b16 a[152:153], v17 offset:0
    ds_read_b64_tr_b16 a[154:155], v17 offset:4096
    s_waitcnt lgkmcnt(6)
    v_mfma_f32_32x32x16_bf16 v[128:143], a[156:159], v[72:75], v[128:143]
    v_mfma_f32_32x32x16_bf16 v[144:159], a[156:159], v[88:91], v[144:159]
    ds_read_b64_tr_b16 a[156:157], v17 offset:8192
    ds_read_b64_tr_b16 a[158:159], v17 offset:12288
    v_mbcnt_lo_u32_b32 v28, -1, 0
    v_mbcnt_hi_u32_b32 v28, -1, v28
    v_lshrrev_b32 v27, 3, v28
    v_and_b32 v28, 7, v28
    v_lshlrev_b32 v23, 9, v27
    v_lshl_add_u32 v26, v28, 4, v23
    v_xor_b32 v28, v28, v27
    v_lshlrev_b32 v27, 7, v27
    v_lshl_add_u32 v27, v28, 4, v27
    v_add_u32 v23, s34, v27
    s_waitcnt lgkmcnt(6)
    v_mfma_f32_32x32x16_bf16 v[160:175], a[144:147], v[64:67], v[160:175]
    v_mfma_f32_32x32x16_bf16 v[176:191], a[144:147], v[80:83], v[176:191]
    ds_read_b64_tr_b16 a[144:145], v14 offset:256
    ds_read_b64_tr_b16 a[146:147], v14 offset:4352
    s_waitcnt lgkmcnt(6)
    v_mfma_f32_32x32x16_bf16 v[160:175], a[148:151], v[72:75], v[160:175]
    s_waitcnt vmcnt(24)
    s_barrier
    v_mfma_f32_32x32x16_bf16 v[176:191], a[148:151], v[88:91], v[176:191]
    ds_read_b64_tr_b16 a[148:149], v14 offset:8448
    ds_read_b64_tr_b16 a[150:151], v14 offset:12544
    s_add_u32 m0, s49, s51
    v_mul_f32 v96, v96, v24
    v_mul_f32 v97, v97, v24
    s_waitcnt lgkmcnt(6)
    v_mfma_f32_32x32x16_bf16 v[192:207], a[152:155], v[64:67], v[192:207]
    buffer_load_dwordx4 v4, s[16:19], s25 offen offset:0 nt lds
    v_mul_f32 v98, v98, v24
    v_mul_f32 v99, v99, v24
    v_mul_f32 v100, v100, v24
    v_mul_f32 v101, v101, v24
    v_mfma_f32_32x32x16_bf16 v[208:223], a[152:155], v[80:83], v[208:223]
    ds_read_b64_tr_b16 a[152:153], v15 offset:256
    ds_read_b64_tr_b16 a[154:155], v15 offset:4352
    buffer_load_dwordx4 v5, s[16:19], s25 offen offset:1024 nt lds
    v_mul_f32 v102, v102, v24
    v_mul_f32 v103, v103, v24
    s_waitcnt lgkmcnt(6)
    v_mfma_f32_32x32x16_bf16 v[192:207], a[156:159], v[72:75], v[192:207]
    buffer_load_dwordx4 v4, s[16:19], s25 offen offset:2048 nt lds
    v_mul_f32 v104, v104, v24
    v_mul_f32 v105, v105, v24
    v_mul_f32 v106, v106, v24
    v_mul_f32 v107, v107, v24
    v_mfma_f32_32x32x16_bf16 v[208:223], a[156:159], v[88:91], v[208:223]
    ds_read_b64_tr_b16 a[156:157], v15 offset:8448
    ds_read_b64_tr_b16 a[158:159], v15 offset:12544
    buffer_load_dwordx4 v5, s[16:19], s25 offen offset:3072 nt lds
    s_waitcnt lgkmcnt(6)
    v_mfma_f32_32x32x16_bf16 v[224:239], a[144:147], v[64:67], v[224:239]
    s_add_u32 s25, s25, 0x4000
    s_add_u32 s51, s51, 0x4000
    s_and_b32 s51, s51, 0xffff
    v_mul_f32 v108, v108, v24
    v_mul_f32 v109, v109, v24
    v_mul_f32 v110, v110, v24
    v_mul_f32 v111, v111, v24
    v_cvt_pk_bf16_f32 v96, v96, v97
    v_mfma_f32_32x32x16_bf16 v[240:255], a[144:147], v[80:83], v[240:255]
    ds_read_b64_tr_b16 a[144:145], v16 offset:256
    ds_read_b64_tr_b16 a[146:147], v16 offset:4352
    v_cvt_pk_bf16_f32 v97, v98, v99
    v_cvt_pk_bf16_f32 v98, v100, v101
    s_waitcnt lgkmcnt(6)
    v_mfma_f32_32x32x16_bf16 v[224:239], a[148:151], v[72:75], v[224:239]
    v_cvt_pk_bf16_f32 v99, v102, v103
    v_cvt_pk_bf16_f32 v100, v104, v105
    v_cvt_pk_bf16_f32 v101, v106, v107
    v_cvt_pk_bf16_f32 v102, v108, v109
    v_cvt_pk_bf16_f32 v103, v110, v111
    v_mfma_f32_32x32x16_bf16 v[240:255], a[148:151], v[88:91], v[240:255]
    ds_read_b64_tr_b16 a[148:149], v16 offset:8448
    ds_read_b64_tr_b16 a[150:151], v16 offset:12544
    v_mbcnt_lo_u32_b32 v111, -1, 0
    v_mbcnt_hi_u32_b32 v111, -1, v111
    v_and_b32 v27, 31, v111
    v_lshrrev_b32 v28, 5, v111
    v_lshlrev_b32 v111, 7, v27
    v_lshl_add_u32 v111, v28, 3, v111
    v_add_u32 v111, s34, v111
    v_and_b32 v27, 7, v27
    v_xor_b32 v28, 0, v27
    v_lshl_add_u32 v104, v28, 4, v111
    v_xor_b32 v28, 1, v27
    v_lshl_add_u32 v105, v28, 4, v111
    v_xor_b32 v28, 2, v27
    v_lshl_add_u32 v106, v28, 4, v111
    v_xor_b32 v28, 3, v27
    v_lshl_add_u32 v107, v28, 4, v111
    v_xor_b32 v28, 4, v27
    v_lshl_add_u32 v108, v28, 4, v111
    v_xor_b32 v28, 5, v27
    v_lshl_add_u32 v109, v28, 4, v111
    v_xor_b32 v28, 6, v27
    v_lshl_add_u32 v110, v28, 4, v111
    v_xor_b32 v28, 7, v27
    v_lshl_add_u32 v111, v28, 4, v111
    s_waitcnt lgkmcnt(6)
    v_mfma_f32_32x32x16_bf16 a[160:175], a[152:155], v[64:67], a[160:175]
    v_mfma_f32_32x32x16_bf16 a[176:191], a[152:155], v[80:83], a[176:191]
    ds_read_b64_tr_b16 a[152:153], v17 offset:256
    ds_read_b64_tr_b16 a[154:155], v17 offset:4352
    s_waitcnt lgkmcnt(6)
    v_mfma_f32_32x32x16_bf16 a[160:175], a[156:159], v[72:75], a[160:175]
    v_mfma_f32_32x32x16_bf16 a[176:191], a[156:159], v[88:91], a[176:191]
    ds_read_b64_tr_b16 a[156:157], v17 offset:8448
    ds_read_b64_tr_b16 a[158:159], v17 offset:12544
    s_waitcnt lgkmcnt(6)
    v_mfma_f32_32x32x16_bf16 a[192:207], a[144:147], v[64:67], a[192:207]
    s_add_u32 s33, s53, 0x4000
    s_and_b32 s33, s33, 0xffff
    s_sub_u32 s54, s33, s53
    s_mov_b32 s53, s33
    v_add_u32 v14, s54, v14
    v_add_u32 v15, s54, v15
    v_add_u32 v16, s54, v16
    v_add_u32 v17, s54, v17
    v_mfma_f32_32x32x16_bf16 a[208:223], a[144:147], v[80:83], a[208:223]
    s_waitcnt vmcnt(12)
    s_waitcnt lgkmcnt(4)
    v_mfma_f32_32x32x16_bf16 a[192:207], a[148:151], v[72:75], a[192:207]
    v_mbcnt_lo_u32_b32 v29, -1, 0
    v_mbcnt_hi_u32_b32 v29, -1, v29
    v_bfe_u32 v29, v29, 3, 2
    s_add_u32 s32, s34, 0x0
    s_sub_u32 s32, s32, s52
    v_mov_b32 v30, s32
    s_add_u32 s32, s34, 0x0
    s_sub_u32 s32, s32, s52
    v_cmp_eq_u32 vcc, 1, v29
    v_mov_b32 v28, s32
    s_nop 0
    v_cndmask_b32 v30, v30, v28, vcc
    s_add_u32 s32, s60, 0xffffe000
    s_sub_u32 s32, s32, s52
    v_cmp_eq_u32 vcc, 2, v29
    v_mov_b32 v28, s32
    s_nop 0
    v_cndmask_b32 v30, v30, v28, vcc
    s_add_u32 s32, s61, 0xffffd000
    s_sub_u32 s32, s32, s52
    v_cmp_eq_u32 vcc, 3, v29
    v_mov_b32 v28, s32
    s_nop 0
    v_cndmask_b32 v30, v30, v28, vcc
    v_mfma_f32_32x32x16_bf16 a[208:223], a[148:151], v[88:91], a[208:223]
    s_waitcnt lgkmcnt(2)
    v_mfma_f32_32x32x16_bf16 a[224:239], a[152:155], v[64:67], a[224:239]
    ds_read_b128 a[128:131], v6 offset:0
    v_mfma_f32_32x32x16_bf16 a[240:255], a[152:155], v[80:83], a[240:255]
    ds_read_b128 a[132:135], v7 offset:0
    s_waitcnt lgkmcnt(2)
    v_mfma_f32_32x32x16_bf16 a[224:239], a[156:159], v[72:75], a[224:239]
    ds_read_b128 a[136:139], v8 offset:0
    v_add_u32 v29, v6, v30
    ds_read_b128 a[64:67], v29 offset:0
    v_add_u32 v29, v7, v30
    ds_read_b128 a[68:71], v29 offset:0
    v_mfma_f32_32x32x16_bf16 a[240:255], a[156:159], v[88:91], a[240:255]
    ds_read_b128 a[140:143], v9 offset:0
    v_add_u32 v29, v8, v30
    ds_read_b128 a[72:75], v29 offset:0
    v_add_u32 v29, v9, v30
    ds_read_b128 a[76:79], v29 offset:0
    v_add_u32 v29, v10, v30
    ds_read_b128 a[80:83], v29 offset:0
    v_add_u32 v29, v11, v30
    ds_read_b128 a[84:87], v29 offset:0
    v_add_u32 v29, v12, v30
    ds_read_b128 a[88:91], v29 offset:0
    v_add_u32 v29, v13, v30
    ds_read_b128 a[92:95], v29 offset:0
    v_add_u32 v29, v6, v30
    ds_read_b128 a[96:99], v29 offset:256
    v_add_u32 v29, v7, v30
    ds_read_b128 a[100:103], v29 offset:256
    v_add_u32 v29, v8, v30
    ds_read_b128 a[104:107], v29 offset:256
    v_add_u32 v29, v9, v30
    ds_read_b128 a[108:111], v29 offset:256
    v_add_u32 v29, v10, v30
    ds_read_b128 a[112:115], v29 offset:256
    v_add_u32 v29, v11, v30
    ds_read_b128 a[116:119], v29 offset:256
    v_add_u32 v29, v12, v30
    ds_read_b128 a[120:123], v29 offset:256
    v_add_u32 v29, v13, v30
    ds_read_b128 a[124:127], v29 offset:256
    s_waitcnt lgkmcnt(0)
    s_waitcnt lgkmcnt(0)
    v_mfma_f32_32x32x16_bf16 v[32:47], a[128:131], a[0:3], 0
    s_add_u32 m0, s26, s50
    ds_write_b64 v104, v[96:97] offset:0
    ds_write_b64 v105, v[98:99] offset:0
    ds_write_b64 v106, v[100:101] offset:0
    ds_write_b64 v107, v[102:103] offset:0
    v_mfma_f32_32x32x16_bf16 v[48:63], a[128:131], a[64:67], 0
    ds_read_b128 a[128:131], v10 offset:0
    buffer_load_dwordx4 v0, s[12:15], s24 offen offset:0 nt lds
    v_mul_f32 v128, v128, v24
    v_mul_f32 v129, v129, v24
    s_waitcnt lgkmcnt(5)
    v_mfma_f32_32x32x16_bf16 v[32:47], a[132:135], a[4:7], v[32:47]
    buffer_load_dwordx4 v1, s[12:15], s24 offen offset:1024 nt lds
    v_mul_f32 v130, v130, v24
    v_mul_f32 v131, v131, v24
    v_mul_f32 v132, v132, v24
    v_mul_f32 v133, v133, v24
    v_mfma_f32_32x32x16_bf16 v[48:63], a[132:135], a[68:71], v[48:63]
    ds_read_b128 a[132:135], v11 offset:0
    buffer_load_dwordx4 v2, s[12:15], s24 offen offset:2048 nt lds
    v_mul_f32 v134, v134, v24
    v_mul_f32 v135, v135, v24
    s_waitcnt lgkmcnt(6)
    v_mfma_f32_32x32x16_bf16 v[32:47], a[136:139], a[8:11], v[32:47]
    buffer_load_dwordx4 v3, s[12:15], s24 offen offset:3072 nt lds
    v_mul_f32 v136, v136, v24
    v_mul_f32 v137, v137, v24
    v_mul_f32 v138, v138, v24
    v_mul_f32 v139, v139, v24
    v_mfma_f32_32x32x16_bf16 v[48:63], a[136:139], a[72:75], v[48:63]
    ds_read_b128 a[136:139], v12 offset:0
    s_add_u32 s24, s24, 0x4000
    s_add_u32 s50, s50, 0x4000
    s_and_b32 s50, s50, 0xffff
    v_mul_f32 v140, v140, v24
    v_mul_f32 v141, v141, v24
    s_waitcnt lgkmcnt(7)
    v_mfma_f32_32x32x16_bf16 v[32:47], a[140:143], a[12:15], v[32:47]
    s_add_u32 m0, s26, s50
    v_mul_f32 v142, v142, v24
    v_mul_f32 v143, v143, v24
    v_cvt_pk_bf16_f32 v128, v128, v129
    v_cvt_pk_bf16_f32 v129, v130, v131
    v_cvt_pk_bf16_f32 v130, v132, v133
    v_mfma_f32_32x32x16_bf16 v[48:63], a[140:143], a[76:79], v[48:63]
    ds_read_b128 a[140:143], v13 offset:0
    buffer_load_dwordx4 v0, s[12:15], s24 offen offset:0 nt lds
    v_cvt_pk_bf16_f32 v131, v134, v135
    v_cvt_pk_bf16_f32 v132, v136, v137
    s_waitcnt lgkmcnt(3)
    v_mfma_f32_32x32x16_bf16 v[32:47], a[128:131], a[16:19], v[32:47]
    buffer_load_dwordx4 v1, s[12:15], s24 offen offset:1024 nt lds
    v_cvt_pk_bf16_f32 v133, v138, v139
    v_cvt_pk_bf16_f32 v134, v140, v141
    v_cvt_pk_bf16_f32 v135, v142, v143
    ds_write_b64 v108, v[128:129] offset:0
    v_mfma_f32_32x32x16_bf16 v[48:63], a[128:131], a[80:83], v[48:63]
    ds_read_b128 a[128:131], v6 offset:256
    buffer_load_dwordx4 v2, s[12:15], s24 offen offset:2048 nt lds
    ds_write_b64 v109, v[130:131] offset:0
    ds_write_b64 v110, v[132:133] offset:0
    s_waitcnt lgkmcnt(6)
    v_mfma_f32_32x32x16_bf16 v[32:47], a[132:135], a[20:23], v[32:47]
    buffer_load_dwordx4 v3, s[12:15], s24 offen offset:3072 nt lds
    ds_write_b64 v111, v[134:135] offset:0
    v_mul_f32 v112, v112, v25
    v_mul_f32 v113, v113, v25
    v_mfma_f32_32x32x16_bf16 v[48:63], a[132:135], a[84:87], v[48:63]
    ds_read_b128 a[132:135], v7 offset:256
    s_add_u32 s24, s24, 0x4000
    s_add_u32 s50, s50, 0x4000
    s_and_b32 s50, s50, 0xffff
    v_mul_f32 v114, v114, v25
    v_mul_f32 v115, v115, v25
    s_waitcnt lgkmcnt(7)
    v_mfma_f32_32x32x16_bf16 v[32:47], a[136:139], a[24:27], v[32:47]
    v_mul_f32 v116, v116, v25
    v_mul_f32 v117, v117, v25
    v_mul_f32 v118, v118, v25
    v_mul_f32 v119, v119, v25
    v_mul_f32 v120, v120, v25
    v_mul_f32 v121, v121, v25
    v_mfma_f32_32x32x16_bf16 v[48:63], a[136:139], a[88:91], v[48:63]
    ds_read_b128 a[136:139], v8 offset:256
    v_mul_f32 v122, v122, v25
    v_mul_f32 v123, v123, v25
    s_waitcnt lgkmcnt(7)
    v_mfma_f32_32x32x16_bf16 v[32:47], a[140:143], a[28:31], v[32:47]
    v_mul_f32 v124, v124, v25
    v_mul_f32 v125, v125, v25
    v_mul_f32 v126, v126, v25
    v_mul_f32 v127, v127, v25
    v_cvt_pk_bf16_f32 v112, v112, v113
    v_cvt_pk_bf16_f32 v113, v114, v115
    v_mfma_f32_32x32x16_bf16 v[48:63], a[140:143], a[92:95], v[48:63]
    ds_read_b128 a[140:143], v9 offset:256
    v_cvt_pk_bf16_f32 v114, v116, v117
    v_cvt_pk_bf16_f32 v115, v118, v119
    v_cvt_pk_bf16_f32 v116, v120, v121
    s_waitcnt lgkmcnt(6)
    v_mfma_f32_32x32x16_bf16 v[32:47], a[128:131], a[32:35], v[32:47]
    v_cvt_pk_bf16_f32 v117, v122, v123
    v_cvt_pk_bf16_f32 v118, v124, v125
    v_cvt_pk_bf16_f32 v119, v126, v127
    ds_write_b64 v104, v[112:113] offset:4096
    ds_write_b64 v105, v[114:115] offset:4096
    v_mfma_f32_32x32x16_bf16 v[48:63], a[128:131], a[96:99], v[48:63]
    ds_read_b128 a[128:131], v10 offset:256
    ds_write_b64 v106, v[116:117] offset:4096
    ds_write_b64 v107, v[118:119] offset:4096
    s_waitcnt lgkmcnt(7)
    v_mfma_f32_32x32x16_bf16 v[32:47], a[132:135], a[36:39], v[32:47]
    ds_read_b128 v[128:131], v23 offset:0
    ds_read_b128 v[132:135], v23 offset:1024
    ds_read_b128 v[136:139], v23 offset:2048
    ds_read_b128 v[140:143], v23 offset:3072
    v_mfma_f32_32x32x16_bf16 v[48:63], a[132:135], a[100:103], v[48:63]
    ds_read_b128 a[132:135], v11 offset:256
    v_mul_f32 v144, v144, v25
    v_mul_f32 v145, v145, v25
    v_mul_f32 v146, v146, v25
    v_mul_f32 v147, v147, v25
    s_waitcnt lgkmcnt(11)
    v_mfma_f32_32x32x16_bf16 v[32:47], a[136:139], a[40:43], v[32:47]
    v_mul_f32 v148, v148, v25
    v_mul_f32 v149, v149, v25
    v_mul_f32 v150, v150, v25
    v_mul_f32 v151, v151, v25
    v_mfma_f32_32x32x16_bf16 v[48:63], a[136:139], a[104:107], v[48:63]
    ds_read_b128 a[136:139], v12 offset:256
    v_mul_f32 v152, v152, v25
    v_mul_f32 v153, v153, v25
    v_mul_f32 v154, v154, v25
    v_mul_f32 v155, v155, v25
    s_waitcnt lgkmcnt(11)
    v_mfma_f32_32x32x16_bf16 v[32:47], a[140:143], a[44:47], v[32:47]
    v_mul_f32 v156, v156, v25
    v_mul_f32 v157, v157, v25
    v_mul_f32 v158, v158, v25
    v_mul_f32 v159, v159, v25
    v_cvt_pk_bf16_f32 v144, v144, v145
    v_mfma_f32_32x32x16_bf16 v[48:63], a[140:143], a[108:111], v[48:63]
    ds_read_b128 a[140:143], v13 offset:256
    v_cvt_pk_bf16_f32 v145, v146, v147
    v_cvt_pk_bf16_f32 v146, v148, v149
    v_cvt_pk_bf16_f32 v147, v150, v151
    s_waitcnt lgkmcnt(9)
    v_mfma_f32_32x32x16_bf16 v[32:47], a[128:131], a[48:51], v[32:47]
    s_add_u32 s33, s52, 0x4000
    s_and_b32 s33, s33, 0xffff
    s_sub_u32 s54, s33, s52
    s_mov_b32 s52, s33
    v_add_u32 v6, s54, v6
    v_add_u32 v7, s54, v7
    v_add_u32 v8, s54, v8
    v_add_u32 v9, s54, v9
    v_add_u32 v10, s54, v10
    v_add_u32 v11, s54, v11
    v_add_u32 v12, s54, v12
    v_add_u32 v13, s54, v13
    v_cvt_pk_bf16_f32 v148, v152, v153
    v_cvt_pk_bf16_f32 v149, v154, v155
    v_cvt_pk_bf16_f32 v150, v156, v157
    v_cvt_pk_bf16_f32 v151, v158, v159
    ds_write_b64 v108, v[144:145] offset:4096
    v_mfma_f32_32x32x16_bf16 v[48:63], a[128:131], a[112:115], v[48:63]
    ds_write_b64 v109, v[146:147] offset:4096
    ds_write_b64 v110, v[148:149] offset:4096
    ds_write_b64 v111, v[150:151] offset:4096
    s_waitcnt lgkmcnt(6)
    v_mfma_f32_32x32x16_bf16 v[32:47], a[132:135], a[52:55], v[32:47]
    s_add_u32 s32, s29, 0x0
    buffer_store_dwordx4 v[128:131], v26, s[20:23], s32 offen offset:0
    s_add_u32 s32, s29, 0x1000
    buffer_store_dwordx4 v[132:135], v26, s[20:23], s32 offen offset:0
    v_mfma_f32_32x32x16_bf16 v[48:63], a[132:135], a[116:119], v[48:63]
    s_waitcnt lgkmcnt(0)
    s_waitcnt vmcnt(14)
    s_barrier
    s_waitcnt lgkmcnt(0)
    v_mfma_f32_32x32x16_bf16 v[32:47], a[136:139], a[56:59], v[32:47]
    ds_read_b128 a[128:131], v6 offset:0
    ds_read_b128 a[132:135], v7 offset:0
    s_add_u32 s32, s29, 0x2000
    buffer_store_dwordx4 v[136:139], v26, s[20:23], s32 offen offset:0
    v_mfma_f32_32x32x16_bf16 v[48:63], a[136:139], a[120:123], v[48:63]
    s_add_u32 s32, s29, 0x3000
    buffer_store_dwordx4 v[140:143], v26, s[20:23], s32 offen offset:0
    v_mul_f32 v160, v160, v24
    v_mul_f32 v161, v161, v24
    s_waitcnt lgkmcnt(2)
    v_mfma_f32_32x32x16_bf16 v[32:47], a[140:143], a[60:63], v[32:47]
    ds_read_b128 a[136:139], v8 offset:0
    v_mul_f32 v162, v162, v24
    v_mul_f32 v163, v163, v24
    v_mul_f32 v164, v164, v24
    v_mul_f32 v165, v165, v24
    v_mfma_f32_32x32x16_bf16 v[48:63], a[140:143], a[124:127], v[48:63]
    ds_read_b128 a[140:143], v9 offset:0
    v_mul_f32 v166, v166, v24
    v_mul_f32 v167, v167, v24
    v_mul_f32 v168, v168, v24
    v_mul_f32 v169, v169, v24
    s_waitcnt lgkmcnt(3)
    v_mfma_f32_32x32x16_bf16 v[64:79], a[128:131], a[0:3], 0
    s_add_u32 m0, s26, s50
    v_mul_f32 v170, v170, v24
    v_mul_f32 v171, v171, v24
    v_mul_f32 v172, v172, v24
    v_mul_f32 v173, v173, v24
    v_mfma_f32_32x32x16_bf16 v[80:95], a[128:131], a[64:67], 0
    ds_read_b128 a[128:131], v10 offset:0
    buffer_load_dwordx4 v0, s[12:15], s24 offen offset:0 nt lds
    v_mul_f32 v174, v174, v24
    v_mul_f32 v175, v175, v24
    s_waitcnt lgkmcnt(3)
    v_mfma_f32_32x32x16_bf16 v[64:79], a[132:135], a[4:7], v[64:79]
    buffer_load_dwordx4 v1, s[12:15], s24 offen offset:1024 nt lds
    v_cvt_pk_bf16_f32 v160, v160, v161
    v_cvt_pk_bf16_f32 v161, v162, v163
    v_cvt_pk_bf16_f32 v162, v164, v165
    v_cvt_pk_bf16_f32 v163, v166, v167
    v_mfma_f32_32x32x16_bf16 v[80:95], a[132:135], a[68:71], v[80:95]
    ds_read_b128 a[132:135], v11 offset:0
    buffer_load_dwordx4 v2, s[12:15], s24 offen offset:2048 nt lds
    v_mul_f32 v32, s28, v32
    v_mul_f32 v33, s28, v33
    s_waitcnt lgkmcnt(3)
    v_mfma_f32_32x32x16_bf16 v[64:79], a[136:139], a[8:11], v[64:79]
    buffer_load_dwordx4 v3, s[12:15], s24 offen offset:3072 nt lds
    v_mul_f32 v34, s28, v34
    v_mul_f32 v35, s28, v35
    v_mul_f32 v36, s28, v36
    v_mul_f32 v37, s28, v37
    v_mfma_f32_32x32x16_bf16 v[80:95], a[136:139], a[72:75], v[80:95]
    ds_read_b128 a[136:139], v12 offset:0
    s_add_u32 s24, s24, 0x4000
    s_add_u32 s50, s50, 0x4000
    s_and_b32 s50, s50, 0xffff
    v_mul_f32 v38, s28, v38
    v_mul_f32 v39, s28, v39
    s_waitcnt lgkmcnt(3)
    v_mfma_f32_32x32x16_bf16 v[64:79], a[140:143], a[12:15], v[64:79]
    v_mul_f32 v40, s28, v40
    v_mul_f32 v41, s28, v41
    v_mul_f32 v42, s28, v42
    v_mul_f32 v43, s28, v43
    v_mul_f32 v44, s28, v44
    v_mfma_f32_32x32x16_bf16 v[80:95], a[140:143], a[76:79], v[80:95]
    ds_read_b128 a[140:143], v13 offset:0
    v_mul_f32 v45, s28, v45
    v_mul_f32 v46, s28, v46
    v_mul_f32 v47, s28, v47
    s_waitcnt lgkmcnt(3)
    v_mfma_f32_32x32x16_bf16 v[64:79], a[128:131], a[16:19], v[64:79]
    v_max3_f32 v22, v32, v33, v34
    v_max3_f32 v22, v22, v35, v36
    v_max3_f32 v22, v22, v37, v38
    v_max3_f32 v22, v22, v39, v40
    v_max3_f32 v22, v22, v41, v42
    v_mfma_f32_32x32x16_bf16 v[80:95], a[128:131], a[80:83], v[80:95]
    ds_read_b128 a[128:131], v6 offset:256
    v_max3_f32 v22, v22, v43, v44
    v_max3_f32 v22, v22, v45, v46
    v_max_f32 v22, v22, v47
    v_mov_b32 v28, v22
    s_nop 1
    v_permlane32_swap_b32 v22, v28
    s_nop 1
    v_max_f32 v18, v22, v28
    v_mov_b32 v20, 0
    s_waitcnt lgkmcnt(3)
    v_mfma_f32_32x32x16_bf16 v[64:79], a[132:135], a[20:23], v[64:79]
    v_mfma_f32_32x32x16_bf16 v[80:95], a[132:135], a[84:87], v[80:95]
    ds_read_b128 a[132:135], v7 offset:256
    s_waitcnt lgkmcnt(3)
    v_mfma_f32_32x32x16_bf16 v[64:79], a[136:139], a[24:27], v[64:79]
    v_sub_f32 v32, v32, v18
    v_sub_f32 v33, v33, v18
    v_sub_f32 v34, v34, v18
    v_sub_f32 v35, v35, v18
    v_sub_f32 v36, v36, v18
    v_mfma_f32_32x32x16_bf16 v[80:95], a[136:139], a[88:91], v[80:95]
    ds_read_b128 a[136:139], v8 offset:256
    v_sub_f32 v37, v37, v18
    v_sub_f32 v38, v38, v18
    v_sub_f32 v39, v39, v18
    s_waitcnt lgkmcnt(3)
    v_mfma_f32_32x32x16_bf16 v[64:79], a[140:143], a[28:31], v[64:79]
    v_sub_f32 v40, v40, v18
    v_sub_f32 v41, v41, v18
    v_sub_f32 v42, v42, v18
    v_sub_f32 v43, v43, v18
    v_sub_f32 v44, v44, v18
    v_mfma_f32_32x32x16_bf16 v[80:95], a[140:143], a[92:95], v[80:95]
    ds_read_b128 a[140:143], v9 offset:256
    v_sub_f32 v45, v45, v18
    v_sub_f32 v46, v46, v18
    v_sub_f32 v47, v47, v18
    s_waitcnt lgkmcnt(3)
    v_mfma_f32_32x32x16_bf16 v[64:79], a[128:131], a[32:35], v[64:79]
    v_mul_f32 v48, s28, v48
    v_mul_f32 v49, s28, v49
    v_mul_f32 v50, s28, v50
    v_mul_f32 v51, s28, v51
    v_mul_f32 v52, s28, v52
    v_mfma_f32_32x32x16_bf16 v[80:95], a[128:131], a[96:99], v[80:95]
    ds_read_b128 a[128:131], v10 offset:256
    v_mul_f32 v53, s28, v53
    v_mul_f32 v54, s28, v54
    v_mul_f32 v55, s28, v55
    s_waitcnt lgkmcnt(3)
    v_mfma_f32_32x32x16_bf16 v[64:79], a[132:135], a[36:39], v[64:79]
    v_mul_f32 v56, s28, v56
    v_mul_f32 v57, s28, v57
    v_mul_f32 v58, s28, v58
    v_mul_f32 v59, s28, v59
    v_mul_f32 v60, s28, v60
    v_mfma_f32_32x32x16_bf16 v[80:95], a[132:135], a[100:103], v[80:95]
    ds_read_b128 a[132:135], v11 offset:256
    v_mul_f32 v61, s28, v61
    v_mul_f32 v62, s28, v62
    v_mul_f32 v63, s28, v63
    s_waitcnt lgkmcnt(3)
    v_mfma_f32_32x32x16_bf16 v[64:79], a[136:139], a[40:43], v[64:79]
    v_max3_f32 v22, v48, v49, v50
    v_max3_f32 v22, v22, v51, v52
    v_max3_f32 v22, v22, v53, v54
    v_max3_f32 v22, v22, v55, v56
    v_max3_f32 v22, v22, v57, v58
    v_mfma_f32_32x32x16_bf16 v[80:95], a[136:139], a[104:107], v[80:95]
    ds_read_b128 a[136:139], v12 offset:256
    v_max3_f32 v22, v22, v59, v60
    v_max3_f32 v22, v22, v61, v62
    v_max_f32 v22, v22, v63
    v_mov_b32 v28, v22
    s_nop 1
    v_permlane32_swap_b32 v22, v28
    s_nop 1
    v_max_f32 v19, v22, v28
    v_mov_b32 v21, 0
    s_waitcnt lgkmcnt(3)
    v_mfma_f32_32x32x16_bf16 v[64:79], a[140:143], a[44:47], v[64:79]
    s_waitcnt vmcnt(20)
    s_barrier
    v_mfma_f32_32x32x16_bf16 v[80:95], a[140:143], a[108:111], v[80:95]
    ds_read_b128 a[140:143], v13 offset:256
    s_waitcnt lgkmcnt(3)
    v_mfma_f32_32x32x16_bf16 v[64:79], a[128:131], a[48:51], v[64:79]
    ds_read_b64_tr_b16 a[144:145], v14 offset:0
    v_sub_f32 v48, v48, v19
    v_sub_f32 v49, v49, v19
    v_mfma_f32_32x32x16_bf16 v[80:95], a[128:131], a[112:115], v[80:95]
    ds_read_b64_tr_b16 a[146:147], v14 offset:4096
    v_sub_f32 v50, v50, v19
    v_sub_f32 v51, v51, v19
    v_sub_f32 v52, v52, v19
    s_waitcnt lgkmcnt(4)
    v_mfma_f32_32x32x16_bf16 v[64:79], a[132:135], a[52:55], v[64:79]
    ds_read_b64_tr_b16 a[148:149], v15 offset:0
    v_sub_f32 v53, v53, v19
    v_sub_f32 v54, v54, v19
    v_sub_f32 v55, v55, v19
    v_sub_f32 v56, v56, v19
    v_mfma_f32_32x32x16_bf16 v[80:95], a[132:135], a[116:119], v[80:95]
    ds_read_b64_tr_b16 a[150:151], v15 offset:4096
    v_sub_f32 v57, v57, v19
    v_sub_f32 v58, v58, v19
    v_sub_f32 v59, v59, v19
    s_waitcnt lgkmcnt(5)
    v_mfma_f32_32x32x16_bf16 v[64:79], a[136:139], a[56:59], v[64:79]
    ds_read_b64_tr_b16 a[152:153], v16 offset:0
    v_sub_f32 v60, v60, v19
    v_sub_f32 v61, v61, v19
    v_sub_f32 v62, v62, v19
    v_sub_f32 v63, v63, v19
    v_mfma_f32_32x32x16_bf16 v[80:95], a[136:139], a[120:123], v[80:95]
    ds_read_b64_tr_b16 a[154:155], v16 offset:4096
    v_exp_f32 v32, v32
    v_cvt_pk_bf16_f32 v164, v168, v169
    s_waitcnt lgkmcnt(6)
    v_mfma_f32_32x32x16_bf16 v[64:79], a[140:143], a[60:63], v[64:79]
    ds_read_b64_tr_b16 a[156:157], v17 offset:0
    v_exp_f32 v33, v33
    v_add_f32 v20, v20, v32
    v_add_f32 v20, v20, v33
    v_mfma_f32_32x32x16_bf16 v[80:95], a[140:143], a[124:127], v[80:95]
    ds_read_b64_tr_b16 a[158:159], v17 offset:4096
    v_cvt_pk_bf16_f32 v32, v32, v33
    v_exp_f32 v34, v34
    v_exp_f32 v35, v35
    v_add_f32 v20, v20, v34
    v_add_f32 v20, v20, v35
    v_cvt_pk_bf16_f32 v33, v34, v35
    v_exp_f32 v36, v36
    v_exp_f32 v37, v37
    v_add_f32 v20, v20, v36
    v_add_f32 v20, v20, v37
    v_cvt_pk_bf16_f32 v34, v36, v37
    v_exp_f32 v38, v38
    v_exp_f32 v39, v39
    v_add_f32 v20, v20, v38
    v_add_f32 v20, v20, v39
    v_cvt_pk_bf16_f32 v35, v38, v39
    v_exp_f32 v48, v48
    v_exp_f32 v49, v49
    v_add_f32 v21, v21, v48
    v_add_f32 v21, v21, v49
    v_cvt_pk_bf16_f32 v48, v48, v49
    v_exp_f32 v50, v50
    v_exp_f32 v51, v51
    v_add_f32 v21, v21, v50
    v_add_f32 v21, v21, v51
    v_cvt_pk_bf16_f32 v49, v50, v51
    v_exp_f32 v52, v52
    v_exp_f32 v53, v53
    v_add_f32 v21, v21, v52
    v_add_f32 v21, v21, v53
    v_cvt_pk_bf16_f32 v50, v52, v53
    v_exp_f32 v54, v54
    v_exp_f32 v55, v55
    v_add_f32 v21, v21, v54
    v_add_f32 v21, v21, v55
    v_cvt_pk_bf16_f32 v51, v54, v55
    v_exp_f32 v40, v40
    v_exp_f32 v41, v41
    v_add_f32 v20, v20, v40
    v_add_f32 v20, v20, v41
    v_cvt_pk_bf16_f32 v40, v40, v41
    v_exp_f32 v42, v42
    v_exp_f32 v43, v43
    v_add_f32 v20, v20, v42
    v_add_f32 v20, v20, v43
    v_cvt_pk_bf16_f32 v41, v42, v43
    v_exp_f32 v44, v44
    v_exp_f32 v45, v45
    v_add_f32 v20, v20, v44
    v_add_f32 v20, v20, v45
    v_cvt_pk_bf16_f32 v42, v44, v45
    v_exp_f32 v46, v46
    v_exp_f32 v47, v47
    v_add_f32 v20, v20, v46
    v_add_f32 v20, v20, v47
    v_cvt_pk_bf16_f32 v43, v46, v47
    v_exp_f32 v56, v56
    v_exp_f32 v57, v57
    v_add_f32 v21, v21, v56
    v_add_f32 v21, v21, v57
    v_cvt_pk_bf16_f32 v56, v56, v57
    v_exp_f32 v58, v58
    v_exp_f32 v59, v59
    v_add_f32 v21, v21, v58
    v_add_f32 v21, v21, v59
    v_cvt_pk_bf16_f32 v57, v58, v59
    v_exp_f32 v60, v60
    v_exp_f32 v61, v61
    v_add_f32 v21, v21, v60
    v_add_f32 v21, v21, v61
    v_cvt_pk_bf16_f32 v58, v60, v61
    v_exp_f32 v62, v62
    v_exp_f32 v63, v63
    v_add_f32 v21, v21, v62
    v_add_f32 v21, v21, v63
    v_cvt_pk_bf16_f32 v59, v62, v63
    v_cvt_pk_bf16_f32 v165, v170, v171
    v_cvt_pk_bf16_f32 v166, v172, v173
    v_cvt_pk_bf16_f32 v167, v174, v175
    ds_write_b64 v104, v[160:161] offset:0
    ds_write_b64 v105, v[162:163] offset:0
    ds_write_b64 v106, v[164:165] offset:0
    ds_write_b64 v107, v[166:167] offset:0
    ds_read_b128 v[144:147], v23 offset:4096
    ds_read_b128 v[148:151], v23 offset:5120
    ds_read_b128 v[152:155], v23 offset:6144
    ds_read_b128 v[156:159], v23 offset:7168
    v_pk_mul_f32 v[192:193], v[192:193], v[24:25] op_sel:[0,0] op_sel_hi:[1,0]
    v_pk_mul_f32 v[194:195], v[194:195], v[24:25] op_sel:[0,0] op_sel_hi:[1,0]
    v_pk_mul_f32 v[196:197], v[196:197], v[24:25] op_sel:[0,0] op_sel_hi:[1,0]
    v_pk_mul_f32 v[198:199], v[198:199], v[24:25] op_sel:[0,0] op_sel_hi:[1,0]
    v_pk_mul_f32 v[200:201], v[200:201], v[24:25] op_sel:[0,0] op_sel_hi:[1,0]
    v_pk_mul_f32 v[202:203], v[202:203], v[24:25] op_sel:[0,0] op_sel_hi:[1,0]
    v_pk_mul_f32 v[204:205], v[204:205], v[24:25] op_sel:[0,0] op_sel_hi:[1,0]
    v_pk_mul_f32 v[206:207], v[206:207], v[24:25] op_sel:[0,0] op_sel_hi:[1,0]
    v_cvt_pk_bf16_f32 v192, v192, v193
    v_cvt_pk_bf16_f32 v193, v194, v195
    v_cvt_pk_bf16_f32 v194, v196, v197
    v_cvt_pk_bf16_f32 v195, v198, v199
    v_cvt_pk_bf16_f32 v196, v200, v201
    v_cvt_pk_bf16_f32 v197, v202, v203
    v_cvt_pk_bf16_f32 v198, v204, v205
    v_cvt_pk_bf16_f32 v199, v206, v207
    ds_write_b64 v108, v[192:193] offset:0
    ds_write_b64 v109, v[194:195] offset:0
    ds_write_b64 v110, v[196:197] offset:0
    ds_write_b64 v111, v[198:199] offset:0
    s_add_u32 s32, s29, 0x4000
    s_waitcnt lgkmcnt(4)
    buffer_store_dwordx4 v[144:147], v26, s[20:23], s32 offen offset:0
    s_add_u32 s32, s29, 0x5000
    buffer_store_dwordx4 v[148:151], v26, s[20:23], s32 offen offset:0
    s_add_u32 s32, s29, 0x6000
    buffer_store_dwordx4 v[152:155], v26, s[20:23], s32 offen offset:0
    s_add_u32 s32, s29, 0x7000
    buffer_store_dwordx4 v[156:159], v26, s[20:23], s32 offen offset:0
    v_pk_mul_f32 v[176:177], v[176:177], v[24:25] op_sel:[0,1] op_sel_hi:[1,1]
    v_pk_mul_f32 v[178:179], v[178:179], v[24:25] op_sel:[0,1] op_sel_hi:[1,1]
    v_pk_mul_f32 v[180:181], v[180:181], v[24:25] op_sel:[0,1] op_sel_hi:[1,1]
    v_pk_mul_f32 v[182:183], v[182:183], v[24:25] op_sel:[0,1] op_sel_hi:[1,1]
    v_pk_mul_f32 v[184:185], v[184:185], v[24:25] op_sel:[0,1] op_sel_hi:[1,1]
    v_pk_mul_f32 v[186:187], v[186:187], v[24:25] op_sel:[0,1] op_sel_hi:[1,1]
    v_pk_mul_f32 v[188:189], v[188:189], v[24:25] op_sel:[0,1] op_sel_hi:[1,1]
    v_pk_mul_f32 v[190:191], v[190:191], v[24:25] op_sel:[0,1] op_sel_hi:[1,1]
    v_cvt_pk_bf16_f32 v176, v176, v177
    v_cvt_pk_bf16_f32 v177, v178, v179
    v_cvt_pk_bf16_f32 v178, v180, v181
    v_cvt_pk_bf16_f32 v179, v182, v183
    v_cvt_pk_bf16_f32 v180, v184, v185
    v_cvt_pk_bf16_f32 v181, v186, v187
    v_cvt_pk_bf16_f32 v182, v188, v189
    v_cvt_pk_bf16_f32 v183, v190, v191
    ds_write_b64 v104, v[176:177] offset:4096
    ds_write_b64 v105, v[178:179] offset:4096
    ds_write_b64 v106, v[180:181] offset:4096
    ds_write_b64 v107, v[182:183] offset:4096
    s_waitcnt lgkmcnt(4)
    ds_read_b128 v[128:131], v23 offset:0
    ds_read_b128 v[132:135], v23 offset:1024
    ds_read_b128 v[136:139], v23 offset:2048
    ds_read_b128 v[140:143], v23 offset:3072
    v_pk_mul_f32 v[208:209], v[208:209], v[24:25] op_sel:[0,1] op_sel_hi:[1,1]
    v_pk_mul_f32 v[210:211], v[210:211], v[24:25] op_sel:[0,1] op_sel_hi:[1,1]
    v_pk_mul_f32 v[212:213], v[212:213], v[24:25] op_sel:[0,1] op_sel_hi:[1,1]
    v_pk_mul_f32 v[214:215], v[214:215], v[24:25] op_sel:[0,1] op_sel_hi:[1,1]
    v_pk_mul_f32 v[216:217], v[216:217], v[24:25] op_sel:[0,1] op_sel_hi:[1,1]
    v_pk_mul_f32 v[218:219], v[218:219], v[24:25] op_sel:[0,1] op_sel_hi:[1,1]
    v_pk_mul_f32 v[220:221], v[220:221], v[24:25] op_sel:[0,1] op_sel_hi:[1,1]
    v_pk_mul_f32 v[222:223], v[222:223], v[24:25] op_sel:[0,1] op_sel_hi:[1,1]
    v_cvt_pk_bf16_f32 v208, v208, v209
    v_cvt_pk_bf16_f32 v209, v210, v211
    v_cvt_pk_bf16_f32 v210, v212, v213
    v_cvt_pk_bf16_f32 v211, v214, v215
    v_cvt_pk_bf16_f32 v212, v216, v217
    v_cvt_pk_bf16_f32 v213, v218, v219
    v_cvt_pk_bf16_f32 v214, v220, v221
    v_cvt_pk_bf16_f32 v215, v222, v223
    ds_write_b64 v108, v[208:209] offset:4096
    ds_write_b64 v109, v[210:211] offset:4096
    ds_write_b64 v110, v[212:213] offset:4096
    ds_write_b64 v111, v[214:215] offset:4096
    s_add_u32 s32, s29, 0x80
    s_waitcnt lgkmcnt(4)
    buffer_store_dwordx4 v[128:131], v26, s[20:23], s32 offen offset:0
    s_add_u32 s32, s29, 0x1080
    buffer_store_dwordx4 v[132:135], v26, s[20:23], s32 offen offset:0
    s_add_u32 s32, s29, 0x2080
    buffer_store_dwordx4 v[136:139], v26, s[20:23], s32 offen offset:0
    s_add_u32 s32, s29, 0x3080
    buffer_store_dwordx4 v[140:143], v26, s[20:23], s32 offen offset:0
    v_pk_mul_f32 v[224:225], v[224:225], v[24:25] op_sel:[0,0] op_sel_hi:[1,0]
    v_pk_mul_f32 v[226:227], v[226:227], v[24:25] op_sel:[0,0] op_sel_hi:[1,0]
    v_pk_mul_f32 v[228:229], v[228:229], v[24:25] op_sel:[0,0] op_sel_hi:[1,0]
    v_pk_mul_f32 v[230:231], v[230:231], v[24:25] op_sel:[0,0] op_sel_hi:[1,0]
    v_pk_mul_f32 v[232:233], v[232:233], v[24:25] op_sel:[0,0] op_sel_hi:[1,0]
    v_pk_mul_f32 v[234:235], v[234:235], v[24:25] op_sel:[0,0] op_sel_hi:[1,0]
    v_pk_mul_f32 v[236:237], v[236:237], v[24:25] op_sel:[0,0] op_sel_hi:[1,0]
    v_pk_mul_f32 v[238:239], v[238:239], v[24:25] op_sel:[0,0] op_sel_hi:[1,0]
    v_cvt_pk_bf16_f32 v224, v224, v225
    v_cvt_pk_bf16_f32 v225, v226, v227
    v_cvt_pk_bf16_f32 v226, v228, v229
    v_cvt_pk_bf16_f32 v227, v230, v231
    v_cvt_pk_bf16_f32 v228, v232, v233
    v_cvt_pk_bf16_f32 v229, v234, v235
    v_cvt_pk_bf16_f32 v230, v236, v237
    v_cvt_pk_bf16_f32 v231, v238, v239
    ds_write_b64 v104, v[224:225] offset:0
    ds_write_b64 v105, v[226:227] offset:0
    ds_write_b64 v106, v[228:229] offset:0
    ds_write_b64 v107, v[230:231] offset:0
    s_waitcnt lgkmcnt(4)
    ds_read_b128 v[144:147], v23 offset:4096
    ds_read_b128 v[148:151], v23 offset:5120
    ds_read_b128 v[152:155], v23 offset:6144
    ds_read_b128 v[156:159], v23 offset:7168
    v_accvgpr_read_b32 v112, a160
    v_accvgpr_read_b32 v113, a161
    v_accvgpr_read_b32 v114, a162
    v_accvgpr_read_b32 v115, a163
    v_accvgpr_read_b32 v116, a164
    v_accvgpr_read_b32 v117, a165
    v_accvgpr_read_b32 v118, a166
    v_accvgpr_read_b32 v119, a167
    v_accvgpr_read_b32 v120, a168
    v_accvgpr_read_b32 v121, a169
    v_accvgpr_read_b32 v122, a170
    v_accvgpr_read_b32 v123, a171
    v_accvgpr_read_b32 v124, a172
    v_accvgpr_read_b32 v125, a173
    v_accvgpr_read_b32 v126, a174
    v_accvgpr_read_b32 v127, a175
    v_pk_mul_f32 v[112:113], v[112:113], v[24:25] op_sel:[0,0] op_sel_hi:[1,0]
    v_pk_mul_f32 v[114:115], v[114:115], v[24:25] op_sel:[0,0] op_sel_hi:[1,0]
    v_pk_mul_f32 v[116:117], v[116:117], v[24:25] op_sel:[0,0] op_sel_hi:[1,0]
    v_pk_mul_f32 v[118:119], v[118:119], v[24:25] op_sel:[0,0] op_sel_hi:[1,0]
    v_pk_mul_f32 v[120:121], v[120:121], v[24:25] op_sel:[0,0] op_sel_hi:[1,0]
    v_pk_mul_f32 v[122:123], v[122:123], v[24:25] op_sel:[0,0] op_sel_hi:[1,0]
    v_pk_mul_f32 v[124:125], v[124:125], v[24:25] op_sel:[0,0] op_sel_hi:[1,0]
    v_pk_mul_f32 v[126:127], v[126:127], v[24:25] op_sel:[0,0] op_sel_hi:[1,0]
    v_cvt_pk_bf16_f32 v112, v112, v113
    v_cvt_pk_bf16_f32 v113, v114, v115
    v_cvt_pk_bf16_f32 v114, v116, v117
    v_cvt_pk_bf16_f32 v115, v118, v119
    v_cvt_pk_bf16_f32 v116, v120, v121
    v_cvt_pk_bf16_f32 v117, v122, v123
    v_cvt_pk_bf16_f32 v118, v124, v125
    v_cvt_pk_bf16_f32 v119, v126, v127
    ds_write_b64 v108, v[112:113] offset:0
    ds_write_b64 v109, v[114:115] offset:0
    ds_write_b64 v110, v[116:117] offset:0
    ds_write_b64 v111, v[118:119] offset:0
    s_add_u32 s32, s29, 0x4080
    s_waitcnt lgkmcnt(4)
    buffer_store_dwordx4 v[144:147], v26, s[20:23], s32 offen offset:0
    s_add_u32 s32, s29, 0x5080
    buffer_store_dwordx4 v[148:151], v26, s[20:23], s32 offen offset:0
    s_add_u32 s32, s29, 0x6080
    buffer_store_dwordx4 v[152:155], v26, s[20:23], s32 offen offset:0
    s_add_u32 s32, s29, 0x7080
    buffer_store_dwordx4 v[156:159], v26, s[20:23], s32 offen offset:0
    v_pk_mul_f32 v[240:241], v[240:241], v[24:25] op_sel:[0,1] op_sel_hi:[1,1]
    v_pk_mul_f32 v[242:243], v[242:243], v[24:25] op_sel:[0,1] op_sel_hi:[1,1]
    v_pk_mul_f32 v[244:245], v[244:245], v[24:25] op_sel:[0,1] op_sel_hi:[1,1]
    v_pk_mul_f32 v[246:247], v[246:247], v[24:25] op_sel:[0,1] op_sel_hi:[1,1]
    v_pk_mul_f32 v[248:249], v[248:249], v[24:25] op_sel:[0,1] op_sel_hi:[1,1]
    v_pk_mul_f32 v[250:251], v[250:251], v[24:25] op_sel:[0,1] op_sel_hi:[1,1]
    v_pk_mul_f32 v[252:253], v[252:253], v[24:25] op_sel:[0,1] op_sel_hi:[1,1]
    v_pk_mul_f32 v[254:255], v[254:255], v[24:25] op_sel:[0,1] op_sel_hi:[1,1]
    v_cvt_pk_bf16_f32 v240, v240, v241
    v_cvt_pk_bf16_f32 v241, v242, v243
    v_cvt_pk_bf16_f32 v242, v244, v245
    v_cvt_pk_bf16_f32 v243, v246, v247
    v_cvt_pk_bf16_f32 v244, v248, v249
    v_cvt_pk_bf16_f32 v245, v250, v251
    v_cvt_pk_bf16_f32 v246, v252, v253
    v_cvt_pk_bf16_f32 v247, v254, v255
    ds_write_b64 v104, v[240:241] offset:4096
    ds_write_b64 v105, v[242:243] offset:4096
    ds_write_b64 v106, v[244:245] offset:4096
    ds_write_b64 v107, v[246:247] offset:4096
    s_waitcnt lgkmcnt(4)
    ds_read_b128 v[128:131], v23 offset:0
    ds_read_b128 v[132:135], v23 offset:1024
    ds_read_b128 v[136:139], v23 offset:2048
    ds_read_b128 v[140:143], v23 offset:3072
    v_accvgpr_read_b32 v112, a176
    v_accvgpr_read_b32 v113, a177
    v_accvgpr_read_b32 v114, a178
    v_accvgpr_read_b32 v115, a179
    v_accvgpr_read_b32 v116, a180
    v_accvgpr_read_b32 v117, a181
    v_accvgpr_read_b32 v118, a182
    v_accvgpr_read_b32 v119, a183
    v_accvgpr_read_b32 v120, a184
    v_accvgpr_read_b32 v121, a185
    v_accvgpr_read_b32 v122, a186
    v_accvgpr_read_b32 v123, a187
    v_accvgpr_read_b32 v124, a188
    v_accvgpr_read_b32 v125, a189
    v_accvgpr_read_b32 v126, a190
    v_accvgpr_read_b32 v127, a191
    v_pk_mul_f32 v[112:113], v[112:113], v[24:25] op_sel:[0,1] op_sel_hi:[1,1]
    v_pk_mul_f32 v[114:115], v[114:115], v[24:25] op_sel:[0,1] op_sel_hi:[1,1]
    v_pk_mul_f32 v[116:117], v[116:117], v[24:25] op_sel:[0,1] op_sel_hi:[1,1]
    v_pk_mul_f32 v[118:119], v[118:119], v[24:25] op_sel:[0,1] op_sel_hi:[1,1]
    v_pk_mul_f32 v[120:121], v[120:121], v[24:25] op_sel:[0,1] op_sel_hi:[1,1]
    v_pk_mul_f32 v[122:123], v[122:123], v[24:25] op_sel:[0,1] op_sel_hi:[1,1]
    v_pk_mul_f32 v[124:125], v[124:125], v[24:25] op_sel:[0,1] op_sel_hi:[1,1]
    v_pk_mul_f32 v[126:127], v[126:127], v[24:25] op_sel:[0,1] op_sel_hi:[1,1]
    v_cvt_pk_bf16_f32 v112, v112, v113
    v_cvt_pk_bf16_f32 v113, v114, v115
    v_cvt_pk_bf16_f32 v114, v116, v117
    v_cvt_pk_bf16_f32 v115, v118, v119
    v_cvt_pk_bf16_f32 v116, v120, v121
    v_cvt_pk_bf16_f32 v117, v122, v123
    v_cvt_pk_bf16_f32 v118, v124, v125
    v_cvt_pk_bf16_f32 v119, v126, v127
    ds_write_b64 v108, v[112:113] offset:4096
    ds_write_b64 v109, v[114:115] offset:4096
    ds_write_b64 v110, v[116:117] offset:4096
    ds_write_b64 v111, v[118:119] offset:4096
    s_add_u32 s32, s29, 0x100
    s_waitcnt lgkmcnt(4)
    buffer_store_dwordx4 v[128:131], v26, s[20:23], s32 offen offset:0
    s_add_u32 s32, s29, 0x1100
    buffer_store_dwordx4 v[132:135], v26, s[20:23], s32 offen offset:0
    s_add_u32 s32, s29, 0x2100
    buffer_store_dwordx4 v[136:139], v26, s[20:23], s32 offen offset:0
    s_add_u32 s32, s29, 0x3100
    buffer_store_dwordx4 v[140:143], v26, s[20:23], s32 offen offset:0
    v_accvgpr_read_b32 v112, a192
    v_accvgpr_read_b32 v113, a193
    v_accvgpr_read_b32 v114, a194
    v_accvgpr_read_b32 v115, a195
    v_accvgpr_read_b32 v116, a196
    v_accvgpr_read_b32 v117, a197
    v_accvgpr_read_b32 v118, a198
    v_accvgpr_read_b32 v119, a199
    v_accvgpr_read_b32 v120, a200
    v_accvgpr_read_b32 v121, a201
    v_accvgpr_read_b32 v122, a202
    v_accvgpr_read_b32 v123, a203
    v_accvgpr_read_b32 v124, a204
    v_accvgpr_read_b32 v125, a205
    v_accvgpr_read_b32 v126, a206
    v_accvgpr_read_b32 v127, a207
    v_pk_mul_f32 v[112:113], v[112:113], v[24:25] op_sel:[0,0] op_sel_hi:[1,0]
    v_pk_mul_f32 v[114:115], v[114:115], v[24:25] op_sel:[0,0] op_sel_hi:[1,0]
    v_pk_mul_f32 v[116:117], v[116:117], v[24:25] op_sel:[0,0] op_sel_hi:[1,0]
    v_pk_mul_f32 v[118:119], v[118:119], v[24:25] op_sel:[0,0] op_sel_hi:[1,0]
    v_pk_mul_f32 v[120:121], v[120:121], v[24:25] op_sel:[0,0] op_sel_hi:[1,0]
    v_pk_mul_f32 v[122:123], v[122:123], v[24:25] op_sel:[0,0] op_sel_hi:[1,0]
    v_pk_mul_f32 v[124:125], v[124:125], v[24:25] op_sel:[0,0] op_sel_hi:[1,0]
    v_pk_mul_f32 v[126:127], v[126:127], v[24:25] op_sel:[0,0] op_sel_hi:[1,0]
    v_cvt_pk_bf16_f32 v112, v112, v113
    v_cvt_pk_bf16_f32 v113, v114, v115
    v_cvt_pk_bf16_f32 v114, v116, v117
    v_cvt_pk_bf16_f32 v115, v118, v119
    v_cvt_pk_bf16_f32 v116, v120, v121
    v_cvt_pk_bf16_f32 v117, v122, v123
    v_cvt_pk_bf16_f32 v118, v124, v125
    v_cvt_pk_bf16_f32 v119, v126, v127
    ds_write_b64 v104, v[112:113] offset:0
    ds_write_b64 v105, v[114:115] offset:0
    ds_write_b64 v106, v[116:117] offset:0
    ds_write_b64 v107, v[118:119] offset:0
    s_waitcnt lgkmcnt(4)
    ds_read_b128 v[144:147], v23 offset:4096
    ds_read_b128 v[148:151], v23 offset:5120
    ds_read_b128 v[152:155], v23 offset:6144
    ds_read_b128 v[156:159], v23 offset:7168
    v_accvgpr_read_b32 v112, a224
    v_accvgpr_read_b32 v113, a225
    v_accvgpr_read_b32 v114, a226
    v_accvgpr_read_b32 v115, a227
    v_accvgpr_read_b32 v116, a228
    v_accvgpr_read_b32 v117, a229
    v_accvgpr_read_b32 v118, a230
    v_accvgpr_read_b32 v119, a231
    v_accvgpr_read_b32 v120, a232
    v_accvgpr_read_b32 v121, a233
    v_accvgpr_read_b32 v122, a234
    v_accvgpr_read_b32 v123, a235
    v_accvgpr_read_b32 v124, a236
    v_accvgpr_read_b32 v125, a237
    v_accvgpr_read_b32 v126, a238
    v_accvgpr_read_b32 v127, a239
    v_pk_mul_f32 v[112:113], v[112:113], v[24:25] op_sel:[0,0] op_sel_hi:[1,0]
    v_pk_mul_f32 v[114:115], v[114:115], v[24:25] op_sel:[0,0] op_sel_hi:[1,0]
    v_pk_mul_f32 v[116:117], v[116:117], v[24:25] op_sel:[0,0] op_sel_hi:[1,0]
    v_pk_mul_f32 v[118:119], v[118:119], v[24:25] op_sel:[0,0] op_sel_hi:[1,0]
    v_pk_mul_f32 v[120:121], v[120:121], v[24:25] op_sel:[0,0] op_sel_hi:[1,0]
    v_pk_mul_f32 v[122:123], v[122:123], v[24:25] op_sel:[0,0] op_sel_hi:[1,0]
    v_pk_mul_f32 v[124:125], v[124:125], v[24:25] op_sel:[0,0] op_sel_hi:[1,0]
    v_pk_mul_f32 v[126:127], v[126:127], v[24:25] op_sel:[0,0] op_sel_hi:[1,0]
    v_cvt_pk_bf16_f32 v112, v112, v113
    v_cvt_pk_bf16_f32 v113, v114, v115
    v_cvt_pk_bf16_f32 v114, v116, v117
    v_cvt_pk_bf16_f32 v115, v118, v119
    v_cvt_pk_bf16_f32 v116, v120, v121
    v_cvt_pk_bf16_f32 v117, v122, v123
    v_cvt_pk_bf16_f32 v118, v124, v125
    v_cvt_pk_bf16_f32 v119, v126, v127
    ds_write_b64 v108, v[112:113] offset:0
    ds_write_b64 v109, v[114:115] offset:0
    ds_write_b64 v110, v[116:117] offset:0
    ds_write_b64 v111, v[118:119] offset:0
    s_add_u32 s32, s29, 0x4100
    s_waitcnt lgkmcnt(4)
    buffer_store_dwordx4 v[144:147], v26, s[20:23], s32 offen offset:0
    s_add_u32 s32, s29, 0x5100
    buffer_store_dwordx4 v[148:151], v26, s[20:23], s32 offen offset:0
    s_add_u32 s32, s29, 0x6100
    buffer_store_dwordx4 v[152:155], v26, s[20:23], s32 offen offset:0
    s_add_u32 s32, s29, 0x7100
    buffer_store_dwordx4 v[156:159], v26, s[20:23], s32 offen offset:0
    v_accvgpr_read_b32 v112, a208
    v_accvgpr_read_b32 v113, a209
    v_accvgpr_read_b32 v114, a210
    v_accvgpr_read_b32 v115, a211
    v_accvgpr_read_b32 v116, a212
    v_accvgpr_read_b32 v117, a213
    v_accvgpr_read_b32 v118, a214
    v_accvgpr_read_b32 v119, a215
    v_accvgpr_read_b32 v120, a216
    v_accvgpr_read_b32 v121, a217
    v_accvgpr_read_b32 v122, a218
    v_accvgpr_read_b32 v123, a219
    v_accvgpr_read_b32 v124, a220
    v_accvgpr_read_b32 v125, a221
    v_accvgpr_read_b32 v126, a222
    v_accvgpr_read_b32 v127, a223
    v_pk_mul_f32 v[112:113], v[112:113], v[24:25] op_sel:[0,1] op_sel_hi:[1,1]
    v_pk_mul_f32 v[114:115], v[114:115], v[24:25] op_sel:[0,1] op_sel_hi:[1,1]
    v_pk_mul_f32 v[116:117], v[116:117], v[24:25] op_sel:[0,1] op_sel_hi:[1,1]
    v_pk_mul_f32 v[118:119], v[118:119], v[24:25] op_sel:[0,1] op_sel_hi:[1,1]
    v_pk_mul_f32 v[120:121], v[120:121], v[24:25] op_sel:[0,1] op_sel_hi:[1,1]
    v_pk_mul_f32 v[122:123], v[122:123], v[24:25] op_sel:[0,1] op_sel_hi:[1,1]
    v_pk_mul_f32 v[124:125], v[124:125], v[24:25] op_sel:[0,1] op_sel_hi:[1,1]
    v_pk_mul_f32 v[126:127], v[126:127], v[24:25] op_sel:[0,1] op_sel_hi:[1,1]
    v_cvt_pk_bf16_f32 v112, v112, v113
    v_cvt_pk_bf16_f32 v113, v114, v115
    v_cvt_pk_bf16_f32 v114, v116, v117
    v_cvt_pk_bf16_f32 v115, v118, v119
    v_cvt_pk_bf16_f32 v116, v120, v121
    v_cvt_pk_bf16_f32 v117, v122, v123
    v_cvt_pk_bf16_f32 v118, v124, v125
    v_cvt_pk_bf16_f32 v119, v126, v127
    ds_write_b64 v104, v[112:113] offset:4096
    ds_write_b64 v105, v[114:115] offset:4096
    ds_write_b64 v106, v[116:117] offset:4096
    ds_write_b64 v107, v[118:119] offset:4096
    s_waitcnt lgkmcnt(4)
    ds_read_b128 v[128:131], v23 offset:0
    ds_read_b128 v[132:135], v23 offset:1024
    ds_read_b128 v[136:139], v23 offset:2048
    ds_read_b128 v[140:143], v23 offset:3072
    v_accvgpr_read_b32 v112, a240
    v_accvgpr_read_b32 v113, a241
    v_accvgpr_read_b32 v114, a242
    v_accvgpr_read_b32 v115, a243
    v_accvgpr_read_b32 v116, a244
    v_accvgpr_read_b32 v117, a245
    v_accvgpr_read_b32 v118, a246
    v_accvgpr_read_b32 v119, a247
    v_accvgpr_read_b32 v120, a248
    v_accvgpr_read_b32 v121, a249
    v_accvgpr_read_b32 v122, a250
    v_accvgpr_read_b32 v123, a251
    v_accvgpr_read_b32 v124, a252
    v_accvgpr_read_b32 v125, a253
    v_accvgpr_read_b32 v126, a254
    v_accvgpr_read_b32 v127, a255
    v_pk_mul_f32 v[112:113], v[112:113], v[24:25] op_sel:[0,1] op_sel_hi:[1,1]
    v_pk_mul_f32 v[114:115], v[114:115], v[24:25] op_sel:[0,1] op_sel_hi:[1,1]
    v_pk_mul_f32 v[116:117], v[116:117], v[24:25] op_sel:[0,1] op_sel_hi:[1,1]
    v_pk_mul_f32 v[118:119], v[118:119], v[24:25] op_sel:[0,1] op_sel_hi:[1,1]
    v_pk_mul_f32 v[120:121], v[120:121], v[24:25] op_sel:[0,1] op_sel_hi:[1,1]
    v_pk_mul_f32 v[122:123], v[122:123], v[24:25] op_sel:[0,1] op_sel_hi:[1,1]
    v_pk_mul_f32 v[124:125], v[124:125], v[24:25] op_sel:[0,1] op_sel_hi:[1,1]
    v_pk_mul_f32 v[126:127], v[126:127], v[24:25] op_sel:[0,1] op_sel_hi:[1,1]
    v_cvt_pk_bf16_f32 v112, v112, v113
    v_cvt_pk_bf16_f32 v113, v114, v115
    v_cvt_pk_bf16_f32 v114, v116, v117
    v_cvt_pk_bf16_f32 v115, v118, v119
    v_cvt_pk_bf16_f32 v116, v120, v121
    v_cvt_pk_bf16_f32 v117, v122, v123
    v_cvt_pk_bf16_f32 v118, v124, v125
    v_cvt_pk_bf16_f32 v119, v126, v127
    ds_write_b64 v108, v[112:113] offset:4096
    ds_write_b64 v109, v[114:115] offset:4096
    ds_write_b64 v110, v[116:117] offset:4096
    ds_write_b64 v111, v[118:119] offset:4096
    s_add_u32 s32, s29, 0x180
    s_waitcnt lgkmcnt(4)
    buffer_store_dwordx4 v[128:131], v26, s[20:23], s32 offen offset:0
    s_add_u32 s32, s29, 0x1180
    buffer_store_dwordx4 v[132:135], v26, s[20:23], s32 offen offset:0
    s_add_u32 s32, s29, 0x2180
    buffer_store_dwordx4 v[136:139], v26, s[20:23], s32 offen offset:0
    s_add_u32 s32, s29, 0x3180
    buffer_store_dwordx4 v[140:143], v26, s[20:23], s32 offen offset:0
    s_waitcnt lgkmcnt(0)
    ds_read_b128 v[144:147], v23 offset:4096
    ds_read_b128 v[148:151], v23 offset:5120
    ds_read_b128 v[152:155], v23 offset:6144
    ds_read_b128 v[156:159], v23 offset:7168
    s_add_u32 s32, s29, 0x4180
    s_waitcnt lgkmcnt(0)
    buffer_store_dwordx4 v[144:147], v26, s[20:23], s32 offen offset:0
    s_add_u32 s32, s29, 0x5180
    buffer_store_dwordx4 v[148:151], v26, s[20:23], s32 offen offset:0
    s_add_u32 s32, s29, 0x6180
    buffer_store_dwordx4 v[152:155], v26, s[20:23], s32 offen offset:0
    s_add_u32 s32, s29, 0x7180
    buffer_store_dwordx4 v[156:159], v26, s[20:23], s32 offen offset:0
    s_nop 1
    s_mov_b32 s29, s31
    s_add_u32 s31, s31, 0x2000000
    s_mov_b32 s55, 1
    s_branch L_body
L_last:
    s_add_u32 s33, s53, 0x4000
    s_and_b32 s33, s33, 0xffff
    s_sub_u32 s54, s33, s53
    s_mov_b32 s53, s33
    v_add_u32 v14, s54, v14
    v_add_u32 v15, s54, v15
    v_add_u32 v16, s54, v16
    v_add_u32 v17, s54, v17
    ds_read_b64_tr_b16 a[144:145], v14 offset:0
    ds_read_b64_tr_b16 a[146:147], v14 offset:4096
    ds_read_b64_tr_b16 a[148:149], v14 offset:8192
    ds_read_b64_tr_b16 a[150:151], v14 offset:12288
    ds_read_b64_tr_b16 a[152:153], v15 offset:0
    ds_read_b64_tr_b16 a[154:155], v15 offset:4096
    ds_read_b64_tr_b16 a[156:157], v15 offset:8192
    ds_read_b64_tr_b16 a[158:159], v15 offset:12288
    v_exp_f32 v64, v64
    v_exp_f32 v65, v65
    v_add_f32 v20, v20, v64
    v_add_f32 v20, v20, v65
    v_cvt_pk_bf16_f32 v64, v64, v65
    v_exp_f32 v66, v66
    v_exp_f32 v67, v67
    v_add_f32 v20, v20, v66
    v_add_f32 v20, v20, v67
    v_cvt_pk_bf16_f32 v65, v66, v67
    v_exp_f32 v68, v68
    v_exp_f32 v69, v69
    v_add_f32 v20, v20, v68
    v_add_f32 v20, v20, v69
    v_cvt_pk_bf16_f32 v66, v68, v69
    v_exp_f32 v70, v70
    v_exp_f32 v71, v71
    v_add_f32 v20, v20, v70
    v_add_f32 v20, v20, v71
    v_cvt_pk_bf16_f32 v67, v70, v71
    v_exp_f32 v80, v80
    v_exp_f32 v81, v81
    v_add_f32 v21, v21, v80
    v_add_f32 v21, v21, v81
    v_cvt_pk_bf16_f32 v80, v80, v81
    v_exp_f32 v82, v82
    v_exp_f32 v83, v83
    v_add_f32 v21, v21, v82
    v_add_f32 v21, v21, v83
    v_cvt_pk_bf16_f32 v81, v82, v83
    v_exp_f32 v84, v84
    v_exp_f32 v85, v85
    v_add_f32 v21, v21, v84
    v_add_f32 v21, v21, v85
    v_cvt_pk_bf16_f32 v82, v84, v85
    v_exp_f32 v86, v86
    v_exp_f32 v87, v87
    v_add_f32 v21, v21, v86
    v_add_f32 v21, v21, v87
    v_cvt_pk_bf16_f32 v83, v86, v87
    v_exp_f32 v72, v72
    v_exp_f32 v73, v73
    v_add_f32 v20, v20, v72
    v_add_f32 v20, v20, v73
    v_cvt_pk_bf16_f32 v72, v72, v73
    v_exp_f32 v74, v74
    v_exp_f32 v75, v75
    v_add_f32 v20, v20, v74
    v_add_f32 v20, v20, v75
    v_cvt_pk_bf16_f32 v73, v74, v75
    v_exp_f32 v76, v76
    v_exp_f32 v77, v77
    v_add_f32 v20, v20, v76
    v_add_f32 v20, v20, v77
    v_cvt_pk_bf16_f32 v74, v76, v77
    v_exp_f32 v78, v78
    v_exp_f32 v79, v79
    v_add_f32 v20, v20, v78
    v_add_f32 v20, v20, v79
    v_cvt_pk_bf16_f32 v75, v78, v79
    v_exp_f32 v88, v88
    v_exp_f32 v89, v89
    v_add_f32 v21, v21, v88
    v_add_f32 v21, v21, v89
    v_cvt_pk_bf16_f32 v88, v88, v89
    v_exp_f32 v90, v90
    v_exp_f32 v91, v91
    v_add_f32 v21, v21, v90
    v_add_f32 v21, v21, v91
    v_cvt_pk_bf16_f32 v89, v90, v91
    v_exp_f32 v92, v92
    v_exp_f32 v93, v93
    v_add_f32 v21, v21, v92
    v_add_f32 v21, v21, v93
    v_cvt_pk_bf16_f32 v90, v92, v93
    v_exp_f32 v94, v94
    v_exp_f32 v95, v95
    v_add_f32 v21, v21, v94
    v_add_f32 v21, v21, v95
    v_cvt_pk_bf16_f32 v91, v94, v95
    s_nop 1
    s_waitcnt vmcnt(0)
    s_waitcnt lgkmcnt(6)
    v_mfma_f32_32x32x16_bf16 v[96:111], a[144:147], v[64:67], v[96:111]
    v_mov_b32 v27, v20
    s_nop 1
    v_permlane32_swap_b32 v20, v27
    s_nop 1
    v_add_f32 v27, v27, v20
    v_rcp_f32 v24, v27
    v_mov_b32 v27, v21
    s_nop 1
    v_permlane32_swap_b32 v21, v27
    s_nop 1
    v_add_f32 v27, v27, v21
    v_rcp_f32 v25, v27
    v_mfma_f32_32x32x16_bf16 v[112:127], a[144:147], v[80:83], v[112:127]
    ds_read_b64_tr_b16 a[144:145], v16 offset:0
    ds_read_b64_tr_b16 a[146:147], v16 offset:4096
    s_waitcnt lgkmcnt(6)
    v_mfma_f32_32x32x16_bf16 v[96:111], a[148:151], v[72:75], v[96:111]
    v_mfma_f32_32x32x16_bf16 v[112:127], a[148:151], v[88:91], v[112:127]
    ds_read_b64_tr_b16 a[148:149], v16 offset:8192
    ds_read_b64_tr_b16 a[150:151], v16 offset:12288
    s_waitcnt lgkmcnt(6)
    v_mfma_f32_32x32x16_bf16 v[128:143], a[152:155], v[64:67], v[128:143]
    v_mbcnt_lo_u32_b32 v28, -1, 0
    v_mbcnt_hi_u32_b32 v28, -1, v28
    v_lshrrev_b32 v27, 3, v28
    v_and_b32 v28, 7, v28
    v_lshlrev_b32 v23, 9, v27
    v_lshl_add_u32 v26, v28, 4, v23
    v_xor_b32 v28, v28, v27
    v_lshlrev_b32 v27, 7, v27
    v_lshl_add_u32 v27, v28, 4, v27
    v_add_u32 v23, s34, v27
    v_mfma_f32_32x32x16_bf16 v[144:159], a[152:155], v[80:83], v[144:159]
    ds_read_b64_tr_b16 a[152:153], v17 offset:0
    ds_read_b64_tr_b16 a[154:155], v17 offset:4096
    s_waitcnt lgkmcnt(6)
    v_mfma_f32_32x32x16_bf16 v[128:143], a[156:159], v[72:75], v[128:143]
    v_mfma_f32_32x32x16_bf16 v[144:159], a[156:159], v[88:91], v[144:159]
    ds_read_b64_tr_b16 a[156:157], v17 offset:8192
    ds_read_b64_tr_b16 a[158:159], v17 offset:12288
    s_waitcnt lgkmcnt(6)
    v_mfma_f32_32x32x16_bf16 v[160:175], a[144:147], v[64:67], v[160:175]
    v_mfma_f32_32x32x16_bf16 v[176:191], a[144:147], v[80:83], v[176:191]
    ds_read_b64_tr_b16 a[144:145], v14 offset:256
    ds_read_b64_tr_b16 a[146:147], v14 offset:4352
    s_waitcnt lgkmcnt(6)
    v_mfma_f32_32x32x16_bf16 v[160:175], a[148:151], v[72:75], v[160:175]
    v_mfma_f32_32x32x16_bf16 v[176:191], a[148:151], v[88:91], v[176:191]
    ds_read_b64_tr_b16 a[148:149], v14 offset:8448
    ds_read_b64_tr_b16 a[150:151], v14 offset:12544
    v_mul_f32 v96, v96, v24
    v_mul_f32 v97, v97, v24
    v_mul_f32 v98, v98, v24
    v_mul_f32 v99, v99, v24
    v_mul_f32 v100, v100, v24
    v_mul_f32 v101, v101, v24
    s_waitcnt lgkmcnt(6)
    v_mfma_f32_32x32x16_bf16 v[192:207], a[152:155], v[64:67], v[192:207]
    v_mul_f32 v102, v102, v24
    v_mul_f32 v103, v103, v24
    v_mul_f32 v104, v104, v24
    v_mul_f32 v105, v105, v24
    v_mul_f32 v106, v106, v24
    v_mul_f32 v107, v107, v24
    v_mfma_f32_32x32x16_bf16 v[208:223], a[152:155], v[80:83], v[208:223]
    ds_read_b64_tr_b16 a[152:153], v15 offset:256
    ds_read_b64_tr_b16 a[154:155], v15 offset:4352
    v_mul_f32 v108, v108, v24
    v_mul_f32 v109, v109, v24
    s_waitcnt lgkmcnt(6)
    v_mfma_f32_32x32x16_bf16 v[192:207], a[156:159], v[72:75], v[192:207]
    v_mul_f32 v110, v110, v24
    v_mul_f32 v111, v111, v24
    v_cvt_pk_bf16_f32 v96, v96, v97
    v_cvt_pk_bf16_f32 v97, v98, v99
    v_cvt_pk_bf16_f32 v98, v100, v101
    v_mfma_f32_32x32x16_bf16 v[208:223], a[156:159], v[88:91], v[208:223]
    ds_read_b64_tr_b16 a[156:157], v15 offset:8448
    ds_read_b64_tr_b16 a[158:159], v15 offset:12544
    v_cvt_pk_bf16_f32 v99, v102, v103
    v_cvt_pk_bf16_f32 v100, v104, v105
    s_waitcnt lgkmcnt(6)
    v_mfma_f32_32x32x16_bf16 v[224:239], a[144:147], v[64:67], v[224:239]
    v_cvt_pk_bf16_f32 v101, v106, v107
    v_cvt_pk_bf16_f32 v102, v108, v109
    v_cvt_pk_bf16_f32 v103, v110, v111
    v_mbcnt_lo_u32_b32 v111, -1, 0
    v_mbcnt_hi_u32_b32 v111, -1, v111
    v_and_b32 v27, 31, v111
    v_lshrrev_b32 v28, 5, v111
    v_lshlrev_b32 v111, 7, v27
    v_lshl_add_u32 v111, v28, 3, v111
    v_add_u32 v111, s34, v111
    v_and_b32 v27, 7, v27
    v_xor_b32 v28, 0, v27
    v_lshl_add_u32 v104, v28, 4, v111
    v_xor_b32 v28, 1, v27
    v_lshl_add_u32 v105, v28, 4, v111
    v_xor_b32 v28, 2, v27
    v_lshl_add_u32 v106, v28, 4, v111
    v_xor_b32 v28, 3, v27
    v_lshl_add_u32 v107, v28, 4, v111
    v_xor_b32 v28, 4, v27
    v_lshl_add_u32 v108, v28, 4, v111
    v_xor_b32 v28, 5, v27
    v_lshl_add_u32 v109, v28, 4, v111
    v_xor_b32 v28, 6, v27
    v_lshl_add_u32 v110, v28, 4, v111
    v_xor_b32 v28, 7, v27
    v_lshl_add_u32 v111, v28, 4, v111
    v_mfma_f32_32x32x16_bf16 v[240:255], a[144:147], v[80:83], v[240:255]
    ds_read_b64_tr_b16 a[144:145], v16 offset:256
    ds_read_b64_tr_b16 a[146:147], v16 offset:4352
    s_waitcnt lgkmcnt(6)
    v_mfma_f32_32x32x16_bf16 v[224:239], a[148:151], v[72:75], v[224:239]
    v_mfma_f32_32x32x16_bf16 v[240:255], a[148:151], v[88:91], v[240:255]
    ds_read_b64_tr_b16 a[148:149], v16 offset:8448
    ds_read_b64_tr_b16 a[150:151], v16 offset:12544
    s_waitcnt lgkmcnt(6)
    v_mfma_f32_32x32x16_bf16 a[160:175], a[152:155], v[64:67], a[160:175]
    v_mfma_f32_32x32x16_bf16 a[176:191], a[152:155], v[80:83], a[176:191]
    ds_read_b64_tr_b16 a[152:153], v17 offset:256
    ds_read_b64_tr_b16 a[154:155], v17 offset:4352
    s_waitcnt lgkmcnt(6)
    v_mfma_f32_32x32x16_bf16 a[160:175], a[156:159], v[72:75], a[160:175]
    v_mfma_f32_32x32x16_bf16 a[176:191], a[156:159], v[88:91], a[176:191]
    ds_read_b64_tr_b16 a[156:157], v17 offset:8448
    ds_read_b64_tr_b16 a[158:159], v17 offset:12544
    ds_write_b64 v104, v[96:97] offset:0
    s_waitcnt lgkmcnt(7)
    v_mfma_f32_32x32x16_bf16 a[192:207], a[144:147], v[64:67], a[192:207]
    ds_write_b64 v105, v[98:99] offset:0
    ds_write_b64 v106, v[100:101] offset:0
    ds_write_b64 v107, v[102:103] offset:0
    v_mul_f32 v128, v128, v24
    v_mul_f32 v129, v129, v24
    v_mfma_f32_32x32x16_bf16 a[208:223], a[144:147], v[80:83], a[208:223]
    v_mul_f32 v130, v130, v24
    v_mul_f32 v131, v131, v24
    v_mul_f32 v132, v132, v24
    v_mul_f32 v133, v133, v24
    s_waitcnt lgkmcnt(8)
    v_mfma_f32_32x32x16_bf16 a[192:207], a[148:151], v[72:75], a[192:207]
    v_mul_f32 v134, v134, v24
    v_mul_f32 v135, v135, v24
    v_mul_f32 v136, v136, v24
    v_mul_f32 v137, v137, v24
    v_mfma_f32_32x32x16_bf16 a[208:223], a[148:151], v[88:91], a[208:223]
    v_mul_f32 v138, v138, v24
    v_mul_f32 v139, v139, v24
    v_mul_f32 v140, v140, v24
    v_mul_f32 v141, v141, v24
    s_waitcnt lgkmcnt(6)
    v_mfma_f32_32x32x16_bf16 a[224:239], a[152:155], v[64:67], a[224:239]
    v_mul_f32 v142, v142, v24
    v_mul_f32 v143, v143, v24
    v_cvt_pk_bf16_f32 v128, v128, v129
    v_cvt_pk_bf16_f32 v129, v130, v131
    v_cvt_pk_bf16_f32 v130, v132, v133
    v_cvt_pk_bf16_f32 v131, v134, v135
    v_mfma_f32_32x32x16_bf16 a[240:255], a[152:155], v[80:83], a[240:255]
    v_cvt_pk_bf16_f32 v132, v136, v137
    v_cvt_pk_bf16_f32 v133, v138, v139
    v_cvt_pk_bf16_f32 v134, v140, v141
    v_cvt_pk_bf16_f32 v135, v142, v143
    s_waitcnt lgkmcnt(4)
    v_mfma_f32_32x32x16_bf16 a[224:239], a[156:159], v[72:75], a[224:239]
    ds_write_b64 v108, v[128:129] offset:0
    ds_write_b64 v109, v[130:131] offset:0
    ds_write_b64 v110, v[132:133] offset:0
    ds_write_b64 v111, v[134:135] offset:0
    v_mfma_f32_32x32x16_bf16 a[240:255], a[156:159], v[88:91], a[240:255]
    v_mul_f32 v112, v112, v25
    v_mul_f32 v113, v113, v25
    v_mul_f32 v114, v114, v25
    v_mul_f32 v115, v115, v25
    s_nop 15
    v_pk_mul_f32 v[116:117], v[116:117], v[24:25] op_sel:[0,1] op_sel_hi:[1,1]
    v_pk_mul_f32 v[118:119], v[118:119], v[24:25] op_sel:[0,1] op_sel_hi:[1,1]
    v_pk_mul_f32 v[120:121], v[120:121], v[24:25] op_sel:[0,1] op_sel_hi:[1,1]
    v_pk_mul_f32 v[122:123], v[122:123], v[24:25] op_sel:[0,1] op_sel_hi:[1,1]
    v_pk_mul_f32 v[124:125], v[124:125], v[24:25] op_sel:[0,1] op_sel_hi:[1,1]
    v_pk_mul_f32 v[126:127], v[126:127], v[24:25] op_sel:[0,1] op_sel_hi:[1,1]
    v_cvt_pk_bf16_f32 v112, v112, v113
    v_cvt_pk_bf16_f32 v113, v114, v115
    v_cvt_pk_bf16_f32 v114, v116, v117
    v_cvt_pk_bf16_f32 v115, v118, v119
    v_cvt_pk_bf16_f32 v116, v120, v121
    v_cvt_pk_bf16_f32 v117, v122, v123
    v_cvt_pk_bf16_f32 v118, v124, v125
    v_cvt_pk_bf16_f32 v119, v126, v127
    ds_write_b64 v104, v[112:113] offset:4096
    ds_write_b64 v105, v[114:115] offset:4096
    ds_write_b64 v106, v[116:117] offset:4096
    ds_write_b64 v107, v[118:119] offset:4096
    s_waitcnt lgkmcnt(4)
    ds_read_b128 v[128:131], v23 offset:0
    ds_read_b128 v[132:135], v23 offset:1024
    ds_read_b128 v[136:139], v23 offset:2048
    ds_read_b128 v[140:143], v23 offset:3072
    v_pk_mul_f32 v[144:145], v[144:145], v[24:25] op_sel:[0,1] op_sel_hi:[1,1]
    v_pk_mul_f32 v[146:147], v[146:147], v[24:25] op_sel:[0,1] op_sel_hi:[1,1]
    v_pk_mul_f32 v[148:149], v[148:149], v[24:25] op_sel:[0,1] op_sel_hi:[1,1]
    v_pk_mul_f32 v[150:151], v[150:151], v[24:25] op_sel:[0,1] op_sel_hi:[1,1]
    v_pk_mul_f32 v[152:153], v[152:153], v[24:25] op_sel:[0,1] op_sel_hi:[1,1]
    v_pk_mul_f32 v[154:155], v[154:155], v[24:25] op_sel:[0,1] op_sel_hi:[1,1]
    v_pk_mul_f32 v[156:157], v[156:157], v[24:25] op_sel:[0,1] op_sel_hi:[1,1]
    v_pk_mul_f32 v[158:159], v[158:159], v[24:25] op_sel:[0,1] op_sel_hi:[1,1]
    v_cvt_pk_bf16_f32 v144, v144, v145
    v_cvt_pk_bf16_f32 v145, v146, v147
    v_cvt_pk_bf16_f32 v146, v148, v149
    v_cvt_pk_bf16_f32 v147, v150, v151
    v_cvt_pk_bf16_f32 v148, v152, v153
    v_cvt_pk_bf16_f32 v149, v154, v155
    v_cvt_pk_bf16_f32 v150, v156, v157
    v_cvt_pk_bf16_f32 v151, v158, v159
    ds_write_b64 v108, v[144:145] offset:4096
    ds_write_b64 v109, v[146:147] offset:4096
    ds_write_b64 v110, v[148:149] offset:4096
    ds_write_b64 v111, v[150:151] offset:4096
    s_add_u32 s32, s29, 0x0
    s_waitcnt lgkmcnt(4)
    buffer_store_dwordx4 v[128:131], v26, s[20:23], s32 offen offset:0
    s_add_u32 s32, s29, 0x1000
    buffer_store_dwordx4 v[132:135], v26, s[20:23], s32 offen offset:0
    s_add_u32 s32, s29, 0x2000
    buffer_store_dwordx4 v[136:139], v26, s[20:23], s32 offen offset:0
    s_add_u32 s32, s29, 0x3000
    buffer_store_dwordx4 v[140:143], v26, s[20:23], s32 offen offset:0
    v_pk_mul_f32 v[160:161], v[160:161], v[24:25] op_sel:[0,0] op_sel_hi:[1,0]
    v_pk_mul_f32 v[162:163], v[162:163], v[24:25] op_sel:[0,0] op_sel_hi:[1,0]
    v_pk_mul_f32 v[164:165], v[164:165], v[24:25] op_sel:[0,0] op_sel_hi:[1,0]
    v_pk_mul_f32 v[166:167], v[166:167], v[24:25] op_sel:[0,0] op_sel_hi:[1,0]
    v_pk_mul_f32 v[168:169], v[168:169], v[24:25] op_sel:[0,0] op_sel_hi:[1,0]
    v_pk_mul_f32 v[170:171], v[170:171], v[24:25] op_sel:[0,0] op_sel_hi:[1,0]
    v_pk_mul_f32 v[172:173], v[172:173], v[24:25] op_sel:[0,0] op_sel_hi:[1,0]
    v_pk_mul_f32 v[174:175], v[174:175], v[24:25] op_sel:[0,0] op_sel_hi:[1,0]
    v_cvt_pk_bf16_f32 v160, v160, v161
    v_cvt_pk_bf16_f32 v161, v162, v163
    v_cvt_pk_bf16_f32 v162, v164, v165
    v_cvt_pk_bf16_f32 v163, v166, v167
    v_cvt_pk_bf16_f32 v164, v168, v169
    v_cvt_pk_bf16_f32 v165, v170, v171
    v_cvt_pk_bf16_f32 v166, v172, v173
    v_cvt_pk_bf16_f32 v167, v174, v175
    ds_write_b64 v104, v[160:161] offset:0
    ds_write_b64 v105, v[162:163] offset:0
    ds_write_b64 v106, v[164:165] offset:0
    ds_write_b64 v107, v[166:167] offset:0
    s_waitcnt lgkmcnt(4)
    ds_read_b128 v[144:147], v23 offset:4096
    ds_read_b128 v[148:151], v23 offset:5120
    ds_read_b128 v[152:155], v23 offset:6144
    ds_read_b128 v[156:159], v23 offset:7168
    v_pk_mul_f32 v[192:193], v[192:193], v[24:25] op_sel:[0,0] op_sel_hi:[1,0]
    v_pk_mul_f32 v[194:195], v[194:195], v[24:25] op_sel:[0,0] op_sel_hi:[1,0]
    v_pk_mul_f32 v[196:197], v[196:197], v[24:25] op_sel:[0,0] op_sel_hi:[1,0]
    v_pk_mul_f32 v[198:199], v[198:199], v[24:25] op_sel:[0,0] op_sel_hi:[1,0]
    v_pk_mul_f32 v[200:201], v[200:201], v[24:25] op_sel:[0,0] op_sel_hi:[1,0]
    v_pk_mul_f32 v[202:203], v[202:203], v[24:25] op_sel:[0,0] op_sel_hi:[1,0]
    v_pk_mul_f32 v[204:205], v[204:205], v[24:25] op_sel:[0,0] op_sel_hi:[1,0]
    v_pk_mul_f32 v[206:207], v[206:207], v[24:25] op_sel:[0,0] op_sel_hi:[1,0]
    v_cvt_pk_bf16_f32 v192, v192, v193
    v_cvt_pk_bf16_f32 v193, v194, v195
    v_cvt_pk_bf16_f32 v194, v196, v197
    v_cvt_pk_bf16_f32 v195, v198, v199
    v_cvt_pk_bf16_f32 v196, v200, v201
    v_cvt_pk_bf16_f32 v197, v202, v203
    v_cvt_pk_bf16_f32 v198, v204, v205
    v_cvt_pk_bf16_f32 v199, v206, v207
    ds_write_b64 v108, v[192:193] offset:0
    ds_write_b64 v109, v[194:195] offset:0
    ds_write_b64 v110, v[196:197] offset:0
    ds_write_b64 v111, v[198:199] offset:0
    s_add_u32 s32, s29, 0x4000
    s_waitcnt lgkmcnt(4)
    buffer_store_dwordx4 v[144:147], v26, s[20:23], s32 offen offset:0
    s_add_u32 s32, s29, 0x5000
    buffer_store_dwordx4 v[148:151], v26, s[20:23], s32 offen offset:0
    s_add_u32 s32, s29, 0x6000
    buffer_store_dwordx4 v[152:155], v26, s[20:23], s32 offen offset:0
    s_add_u32 s32, s29, 0x7000
    buffer_store_dwordx4 v[156:159], v26, s[20:23], s32 offen offset:0
    v_pk_mul_f32 v[176:177], v[176:177], v[24:25] op_sel:[0,1] op_sel_hi:[1,1]
    v_pk_mul_f32 v[178:179], v[178:179], v[24:25] op_sel:[0,1] op_sel_hi:[1,1]
    v_pk_mul_f32 v[180:181], v[180:181], v[24:25] op_sel:[0,1] op_sel_hi:[1,1]
    v_pk_mul_f32 v[182:183], v[182:183], v[24:25] op_sel:[0,1] op_sel_hi:[1,1]
    v_pk_mul_f32 v[184:185], v[184:185], v[24:25] op_sel:[0,1] op_sel_hi:[1,1]
    v_pk_mul_f32 v[186:187], v[186:187], v[24:25] op_sel:[0,1] op_sel_hi:[1,1]
    v_pk_mul_f32 v[188:189], v[188:189], v[24:25] op_sel:[0,1] op_sel_hi:[1,1]
    v_pk_mul_f32 v[190:191], v[190:191], v[24:25] op_sel:[0,1] op_sel_hi:[1,1]
    v_cvt_pk_bf16_f32 v176, v176, v177
    v_cvt_pk_bf16_f32 v177, v178, v179
    v_cvt_pk_bf16_f32 v178, v180, v181
    v_cvt_pk_bf16_f32 v179, v182, v183
    v_cvt_pk_bf16_f32 v180, v184, v185
    v_cvt_pk_bf16_f32 v181, v186, v187
    v_cvt_pk_bf16_f32 v182, v188, v189
    v_cvt_pk_bf16_f32 v183, v190, v191
    ds_write_b64 v104, v[176:177] offset:4096
    ds_write_b64 v105, v[178:179] offset:4096
    ds_write_b64 v106, v[180:181] offset:4096
    ds_write_b64 v107, v[182:183] offset:4096
    s_waitcnt lgkmcnt(4)
    ds_read_b128 v[128:131], v23 offset:0
    ds_read_b128 v[132:135], v23 offset:1024
    ds_read_b128 v[136:139], v23 offset:2048
    ds_read_b128 v[140:143], v23 offset:3072
    v_pk_mul_f32 v[208:209], v[208:209], v[24:25] op_sel:[0,1] op_sel_hi:[1,1]
    v_pk_mul_f32 v[210:211], v[210:211], v[24:25] op_sel:[0,1] op_sel_hi:[1,1]
    v_pk_mul_f32 v[212:213], v[212:213], v[24:25] op_sel:[0,1] op_sel_hi:[1,1]
    v_pk_mul_f32 v[214:215], v[214:215], v[24:25] op_sel:[0,1] op_sel_hi:[1,1]
    v_pk_mul_f32 v[216:217], v[216:217], v[24:25] op_sel:[0,1] op_sel_hi:[1,1]
    v_pk_mul_f32 v[218:219], v[218:219], v[24:25] op_sel:[0,1] op_sel_hi:[1,1]
    v_pk_mul_f32 v[220:221], v[220:221], v[24:25] op_sel:[0,1] op_sel_hi:[1,1]
    v_pk_mul_f32 v[222:223], v[222:223], v[24:25] op_sel:[0,1] op_sel_hi:[1,1]
    v_cvt_pk_bf16_f32 v208, v208, v209
    v_cvt_pk_bf16_f32 v209, v210, v211
    v_cvt_pk_bf16_f32 v210, v212, v213
    v_cvt_pk_bf16_f32 v211, v214, v215
    v_cvt_pk_bf16_f32 v212, v216, v217
    v_cvt_pk_bf16_f32 v213, v218, v219
    v_cvt_pk_bf16_f32 v214, v220, v221
    v_cvt_pk_bf16_f32 v215, v222, v223
    ds_write_b64 v108, v[208:209] offset:4096
    ds_write_b64 v109, v[210:211] offset:4096
    ds_write_b64 v110, v[212:213] offset:4096
    ds_write_b64 v111, v[214:215] offset:4096
    s_add_u32 s32, s29, 0x80
    s_waitcnt lgkmcnt(4)
    buffer_store_dwordx4 v[128:131], v26, s[20:23], s32 offen offset:0
    s_add_u32 s32, s29, 0x1080
    buffer_store_dwordx4 v[132:135], v26, s[20:23], s32 offen offset:0
    s_add_u32 s32, s29, 0x2080
    buffer_store_dwordx4 v[136:139], v26, s[20:23], s32 offen offset:0
    s_add_u32 s32, s29, 0x3080
    buffer_store_dwordx4 v[140:143], v26, s[20:23], s32 offen offset:0
    v_pk_mul_f32 v[224:225], v[224:225], v[24:25] op_sel:[0,0] op_sel_hi:[1,0]
    v_pk_mul_f32 v[226:227], v[226:227], v[24:25] op_sel:[0,0] op_sel_hi:[1,0]
    v_pk_mul_f32 v[228:229], v[228:229], v[24:25] op_sel:[0,0] op_sel_hi:[1,0]
    v_pk_mul_f32 v[230:231], v[230:231], v[24:25] op_sel:[0,0] op_sel_hi:[1,0]
    v_pk_mul_f32 v[232:233], v[232:233], v[24:25] op_sel:[0,0] op_sel_hi:[1,0]
    v_pk_mul_f32 v[234:235], v[234:235], v[24:25] op_sel:[0,0] op_sel_hi:[1,0]
    v_pk_mul_f32 v[236:237], v[236:237], v[24:25] op_sel:[0,0] op_sel_hi:[1,0]
    v_pk_mul_f32 v[238:239], v[238:239], v[24:25] op_sel:[0,0] op_sel_hi:[1,0]
    v_cvt_pk_bf16_f32 v224, v224, v225
    v_cvt_pk_bf16_f32 v225, v226, v227
    v_cvt_pk_bf16_f32 v226, v228, v229
    v_cvt_pk_bf16_f32 v227, v230, v231
    v_cvt_pk_bf16_f32 v228, v232, v233
    v_cvt_pk_bf16_f32 v229, v234, v235
    v_cvt_pk_bf16_f32 v230, v236, v237
    v_cvt_pk_bf16_f32 v231, v238, v239
    ds_write_b64 v104, v[224:225] offset:0
    ds_write_b64 v105, v[226:227] offset:0
    ds_write_b64 v106, v[228:229] offset:0
    ds_write_b64 v107, v[230:231] offset:0
    s_waitcnt lgkmcnt(4)
    ds_read_b128 v[144:147], v23 offset:4096
    ds_read_b128 v[148:151], v23 offset:5120
    ds_read_b128 v[152:155], v23 offset:6144
    ds_read_b128 v[156:159], v23 offset:7168
    v_accvgpr_read_b32 v112, a160
    v_accvgpr_read_b32 v113, a161
    v_accvgpr_read_b32 v114, a162
    v_accvgpr_read_b32 v115, a163
    v_accvgpr_read_b32 v116, a164
    v_accvgpr_read_b32 v117, a165
    v_accvgpr_read_b32 v118, a166
    v_accvgpr_read_b32 v119, a167
    v_accvgpr_read_b32 v120, a168
    v_accvgpr_read_b32 v121, a169
    v_accvgpr_read_b32 v122, a170
    v_accvgpr_read_b32 v123, a171
    v_accvgpr_read_b32 v124, a172
    v_accvgpr_read_b32 v125, a173
    v_accvgpr_read_b32 v126, a174
    v_accvgpr_read_b32 v127, a175
    v_pk_mul_f32 v[112:113], v[112:113], v[24:25] op_sel:[0,0] op_sel_hi:[1,0]
    v_pk_mul_f32 v[114:115], v[114:115], v[24:25] op_sel:[0,0] op_sel_hi:[1,0]
    v_pk_mul_f32 v[116:117], v[116:117], v[24:25] op_sel:[0,0] op_sel_hi:[1,0]
    v_pk_mul_f32 v[118:119], v[118:119], v[24:25] op_sel:[0,0] op_sel_hi:[1,0]
    v_pk_mul_f32 v[120:121], v[120:121], v[24:25] op_sel:[0,0] op_sel_hi:[1,0]
    v_pk_mul_f32 v[122:123], v[122:123], v[24:25] op_sel:[0,0] op_sel_hi:[1,0]
    v_pk_mul_f32 v[124:125], v[124:125], v[24:25] op_sel:[0,0] op_sel_hi:[1,0]
    v_pk_mul_f32 v[126:127], v[126:127], v[24:25] op_sel:[0,0] op_sel_hi:[1,0]
    v_cvt_pk_bf16_f32 v112, v112, v113
    v_cvt_pk_bf16_f32 v113, v114, v115
    v_cvt_pk_bf16_f32 v114, v116, v117
    v_cvt_pk_bf16_f32 v115, v118, v119
    v_cvt_pk_bf16_f32 v116, v120, v121
    v_cvt_pk_bf16_f32 v117, v122, v123
    v_cvt_pk_bf16_f32 v118, v124, v125
    v_cvt_pk_bf16_f32 v119, v126, v127
    ds_write_b64 v108, v[112:113] offset:0
    ds_write_b64 v109, v[114:115] offset:0
    ds_write_b64 v110, v[116:117] offset:0
    ds_write_b64 v111, v[118:119] offset:0
    s_add_u32 s32, s29, 0x4080
    s_waitcnt lgkmcnt(4)
    buffer_store_dwordx4 v[144:147], v26, s[20:23], s32 offen offset:0
    s_add_u32 s32, s29, 0x5080
    buffer_store_dwordx4 v[148:151], v26, s[20:23], s32 offen offset:0
    s_add_u32 s32, s29, 0x6080
    buffer_store_dwordx4 v[152:155], v26, s[20:23], s32 offen offset:0
    s_add_u32 s32, s29, 0x7080
    buffer_store_dwordx4 v[156:159], v26, s[20:23], s32 offen offset:0
    v_pk_mul_f32 v[240:241], v[240:241], v[24:25] op_sel:[0,1] op_sel_hi:[1,1]
    v_pk_mul_f32 v[242:243], v[242:243], v[24:25] op_sel:[0,1] op_sel_hi:[1,1]
    v_pk_mul_f32 v[244:245], v[244:245], v[24:25] op_sel:[0,1] op_sel_hi:[1,1]
    v_pk_mul_f32 v[246:247], v[246:247], v[24:25] op_sel:[0,1] op_sel_hi:[1,1]
    v_pk_mul_f32 v[248:249], v[248:249], v[24:25] op_sel:[0,1] op_sel_hi:[1,1]
    v_pk_mul_f32 v[250:251], v[250:251], v[24:25] op_sel:[0,1] op_sel_hi:[1,1]
    v_pk_mul_f32 v[252:253], v[252:253], v[24:25] op_sel:[0,1] op_sel_hi:[1,1]
    v_pk_mul_f32 v[254:255], v[254:255], v[24:25] op_sel:[0,1] op_sel_hi:[1,1]
    v_cvt_pk_bf16_f32 v240, v240, v241
    v_cvt_pk_bf16_f32 v241, v242, v243
    v_cvt_pk_bf16_f32 v242, v244, v245
    v_cvt_pk_bf16_f32 v243, v246, v247
    v_cvt_pk_bf16_f32 v244, v248, v249
    v_cvt_pk_bf16_f32 v245, v250, v251
    v_cvt_pk_bf16_f32 v246, v252, v253
    v_cvt_pk_bf16_f32 v247, v254, v255
    ds_write_b64 v104, v[240:241] offset:4096
    ds_write_b64 v105, v[242:243] offset:4096
    ds_write_b64 v106, v[244:245] offset:4096
    ds_write_b64 v107, v[246:247] offset:4096
    s_waitcnt lgkmcnt(4)
    ds_read_b128 v[128:131], v23 offset:0
    ds_read_b128 v[132:135], v23 offset:1024
    ds_read_b128 v[136:139], v23 offset:2048
    ds_read_b128 v[140:143], v23 offset:3072
    v_accvgpr_read_b32 v112, a176
    v_accvgpr_read_b32 v113, a177
    v_accvgpr_read_b32 v114, a178
    v_accvgpr_read_b32 v115, a179
    v_accvgpr_read_b32 v116, a180
    v_accvgpr_read_b32 v117, a181
    v_accvgpr_read_b32 v118, a182
    v_accvgpr_read_b32 v119, a183
    v_accvgpr_read_b32 v120, a184
    v_accvgpr_read_b32 v121, a185
    v_accvgpr_read_b32 v122, a186
    v_accvgpr_read_b32 v123, a187
    v_accvgpr_read_b32 v124, a188
    v_accvgpr_read_b32 v125, a189
    v_accvgpr_read_b32 v126, a190
    v_accvgpr_read_b32 v127, a191
    v_pk_mul_f32 v[112:113], v[112:113], v[24:25] op_sel:[0,1] op_sel_hi:[1,1]
    v_pk_mul_f32 v[114:115], v[114:115], v[24:25] op_sel:[0,1] op_sel_hi:[1,1]
    v_pk_mul_f32 v[116:117], v[116:117], v[24:25] op_sel:[0,1] op_sel_hi:[1,1]
    v_pk_mul_f32 v[118:119], v[118:119], v[24:25] op_sel:[0,1] op_sel_hi:[1,1]
    v_pk_mul_f32 v[120:121], v[120:121], v[24:25] op_sel:[0,1] op_sel_hi:[1,1]
    v_pk_mul_f32 v[122:123], v[122:123], v[24:25] op_sel:[0,1] op_sel_hi:[1,1]
    v_pk_mul_f32 v[124:125], v[124:125], v[24:25] op_sel:[0,1] op_sel_hi:[1,1]
    v_pk_mul_f32 v[126:127], v[126:127], v[24:25] op_sel:[0,1] op_sel_hi:[1,1]
    v_cvt_pk_bf16_f32 v112, v112, v113
    v_cvt_pk_bf16_f32 v113, v114, v115
    v_cvt_pk_bf16_f32 v114, v116, v117
    v_cvt_pk_bf16_f32 v115, v118, v119
    v_cvt_pk_bf16_f32 v116, v120, v121
    v_cvt_pk_bf16_f32 v117, v122, v123
    v_cvt_pk_bf16_f32 v118, v124, v125
    v_cvt_pk_bf16_f32 v119, v126, v127
    ds_write_b64 v108, v[112:113] offset:4096
    ds_write_b64 v109, v[114:115] offset:4096
    ds_write_b64 v110, v[116:117] offset:4096
    ds_write_b64 v111, v[118:119] offset:4096
    s_add_u32 s32, s29, 0x100
    s_waitcnt lgkmcnt(4)
    buffer_store_dwordx4 v[128:131], v26, s[20:23], s32 offen offset:0
    s_add_u32 s32, s29, 0x1100
    buffer_store_dwordx4 v[132:135], v26, s[20:23], s32 offen offset:0
    s_add_u32 s32, s29, 0x2100
    buffer_store_dwordx4 v[136:139], v26, s[20:23], s32 offen offset:0
    s_add_u32 s32, s29, 0x3100
    buffer_store_dwordx4 v[140:143], v26, s[20:23], s32 offen offset:0
    v_accvgpr_read_b32 v112, a192
    v_accvgpr_read_b32 v113, a193
    v_accvgpr_read_b32 v114, a194
    v_accvgpr_read_b32 v115, a195
    v_accvgpr_read_b32 v116, a196
    v_accvgpr_read_b32 v117, a197
    v_accvgpr_read_b32 v118, a198
    v_accvgpr_read_b32 v119, a199
    v_accvgpr_read_b32 v120, a200
    v_accvgpr_read_b32 v121, a201
    v_accvgpr_read_b32 v122, a202
    v_accvgpr_read_b32 v123, a203
    v_accvgpr_read_b32 v124, a204
    v_accvgpr_read_b32 v125, a205
    v_accvgpr_read_b32 v126, a206
    v_accvgpr_read_b32 v127, a207
    v_pk_mul_f32 v[112:113], v[112:113], v[24:25] op_sel:[0,0] op_sel_hi:[1,0]
    v_pk_mul_f32 v[114:115], v[114:115], v[24:25] op_sel:[0,0] op_sel_hi:[1,0]
    v_pk_mul_f32 v[116:117], v[116:117], v[24:25] op_sel:[0,0] op_sel_hi:[1,0]
    v_pk_mul_f32 v[118:119], v[118:119], v[24:25] op_sel:[0,0] op_sel_hi:[1,0]
    v_pk_mul_f32 v[120:121], v[120:121], v[24:25] op_sel:[0,0] op_sel_hi:[1,0]
    v_pk_mul_f32 v[122:123], v[122:123], v[24:25] op_sel:[0,0] op_sel_hi:[1,0]
    v_pk_mul_f32 v[124:125], v[124:125], v[24:25] op_sel:[0,0] op_sel_hi:[1,0]
    v_pk_mul_f32 v[126:127], v[126:127], v[24:25] op_sel:[0,0] op_sel_hi:[1,0]
    v_cvt_pk_bf16_f32 v112, v112, v113
    v_cvt_pk_bf16_f32 v113, v114, v115
    v_cvt_pk_bf16_f32 v114, v116, v117
    v_cvt_pk_bf16_f32 v115, v118, v119
    v_cvt_pk_bf16_f32 v116, v120, v121
    v_cvt_pk_bf16_f32 v117, v122, v123
    v_cvt_pk_bf16_f32 v118, v124, v125
    v_cvt_pk_bf16_f32 v119, v126, v127
    ds_write_b64 v104, v[112:113] offset:0
    ds_write_b64 v105, v[114:115] offset:0
    ds_write_b64 v106, v[116:117] offset:0
    ds_write_b64 v107, v[118:119] offset:0
    s_waitcnt lgkmcnt(4)
    ds_read_b128 v[144:147], v23 offset:4096
    ds_read_b128 v[148:151], v23 offset:5120
    ds_read_b128 v[152:155], v23 offset:6144
    ds_read_b128 v[156:159], v23 offset:7168
    v_accvgpr_read_b32 v112, a224
    v_accvgpr_read_b32 v113, a225
    v_accvgpr_read_b32 v114, a226
    v_accvgpr_read_b32 v115, a227
    v_accvgpr_read_b32 v116, a228
    v_accvgpr_read_b32 v117, a229
    v_accvgpr_read_b32 v118, a230
    v_accvgpr_read_b32 v119, a231
    v_accvgpr_read_b32 v120, a232
    v_accvgpr_read_b32 v121, a233
    v_accvgpr_read_b32 v122, a234
    v_accvgpr_read_b32 v123, a235
    v_accvgpr_read_b32 v124, a236
    v_accvgpr_read_b32 v125, a237
    v_accvgpr_read_b32 v126, a238
    v_accvgpr_read_b32 v127, a239
    v_pk_mul_f32 v[112:113], v[112:113], v[24:25] op_sel:[0,0] op_sel_hi:[1,0]
    v_pk_mul_f32 v[114:115], v[114:115], v[24:25] op_sel:[0,0] op_sel_hi:[1,0]
    v_pk_mul_f32 v[116:117], v[116:117], v[24:25] op_sel:[0,0] op_sel_hi:[1,0]
    v_pk_mul_f32 v[118:119], v[118:119], v[24:25] op_sel:[0,0] op_sel_hi:[1,0]
    v_pk_mul_f32 v[120:121], v[120:121], v[24:25] op_sel:[0,0] op_sel_hi:[1,0]
    v_pk_mul_f32 v[122:123], v[122:123], v[24:25] op_sel:[0,0] op_sel_hi:[1,0]
    v_pk_mul_f32 v[124:125], v[124:125], v[24:25] op_sel:[0,0] op_sel_hi:[1,0]
    v_pk_mul_f32 v[126:127], v[126:127], v[24:25] op_sel:[0,0] op_sel_hi:[1,0]
    v_cvt_pk_bf16_f32 v112, v112, v113
    v_cvt_pk_bf16_f32 v113, v114, v115
    v_cvt_pk_bf16_f32 v114, v116, v117
    v_cvt_pk_bf16_f32 v115, v118, v119
    v_cvt_pk_bf16_f32 v116, v120, v121
    v_cvt_pk_bf16_f32 v117, v122, v123
    v_cvt_pk_bf16_f32 v118, v124, v125
    v_cvt_pk_bf16_f32 v119, v126, v127
    ds_write_b64 v108, v[112:113] offset:0
    ds_write_b64 v109, v[114:115] offset:0
    ds_write_b64 v110, v[116:117] offset:0
    ds_write_b64 v111, v[118:119] offset:0
    s_add_u32 s32, s29, 0x4100
    s_waitcnt lgkmcnt(4)
    buffer_store_dwordx4 v[144:147], v26, s[20:23], s32 offen offset:0
    s_add_u32 s32, s29, 0x5100
    buffer_store_dwordx4 v[148:151], v26, s[20:23], s32 offen offset:0
    s_add_u32 s32, s29, 0x6100
    buffer_store_dwordx4 v[152:155], v26, s[20:23], s32 offen offset:0
    s_add_u32 s32, s29, 0x7100
    buffer_store_dwordx4 v[156:159], v26, s[20:23], s32 offen offset:0
    v_accvgpr_read_b32 v112, a208
    v_accvgpr_read_b32 v113, a209
    v_accvgpr_read_b32 v114, a210
    v_accvgpr_read_b32 v115, a211
    v_accvgpr_read_b32 v116, a212
    v_accvgpr_read_b32 v117, a213
    v_accvgpr_read_b32 v118, a214
    v_accvgpr_read_b32 v119, a215
    v_accvgpr_read_b32 v120, a216
    v_accvgpr_read_b32 v121, a217
    v_accvgpr_read_b32 v122, a218
    v_accvgpr_read_b32 v123, a219
    v_accvgpr_read_b32 v124, a220
    v_accvgpr_read_b32 v125, a221
    v_accvgpr_read_b32 v126, a222
    v_accvgpr_read_b32 v127, a223
    v_pk_mul_f32 v[112:113], v[112:113], v[24:25] op_sel:[0,1] op_sel_hi:[1,1]
    v_pk_mul_f32 v[114:115], v[114:115], v[24:25] op_sel:[0,1] op_sel_hi:[1,1]
    v_pk_mul_f32 v[116:117], v[116:117], v[24:25] op_sel:[0,1] op_sel_hi:[1,1]
    v_pk_mul_f32 v[118:119], v[118:119], v[24:25] op_sel:[0,1] op_sel_hi:[1,1]
    v_pk_mul_f32 v[120:121], v[120:121], v[24:25] op_sel:[0,1] op_sel_hi:[1,1]
    v_pk_mul_f32 v[122:123], v[122:123], v[24:25] op_sel:[0,1] op_sel_hi:[1,1]
    v_pk_mul_f32 v[124:125], v[124:125], v[24:25] op_sel:[0,1] op_sel_hi:[1,1]
    v_pk_mul_f32 v[126:127], v[126:127], v[24:25] op_sel:[0,1] op_sel_hi:[1,1]
    v_cvt_pk_bf16_f32 v112, v112, v113
    v_cvt_pk_bf16_f32 v113, v114, v115
    v_cvt_pk_bf16_f32 v114, v116, v117
    v_cvt_pk_bf16_f32 v115, v118, v119
    v_cvt_pk_bf16_f32 v116, v120, v121
    v_cvt_pk_bf16_f32 v117, v122, v123
    v_cvt_pk_bf16_f32 v118, v124, v125
    v_cvt_pk_bf16_f32 v119, v126, v127
    ds_write_b64 v104, v[112:113] offset:4096
    ds_write_b64 v105, v[114:115] offset:4096
    ds_write_b64 v106, v[116:117] offset:4096
    ds_write_b64 v107, v[118:119] offset:4096
    s_waitcnt lgkmcnt(4)
    ds_read_b128 v[128:131], v23 offset:0
    ds_read_b128 v[132:135], v23 offset:1024
    ds_read_b128 v[136:139], v23 offset:2048
    ds_read_b128 v[140:143], v23 offset:3072
    v_accvgpr_read_b32 v112, a240
    v_accvgpr_read_b32 v113, a241
    v_accvgpr_read_b32 v114, a242
    v_accvgpr_read_b32 v115, a243
    v_accvgpr_read_b32 v116, a244
    v_accvgpr_read_b32 v117, a245
    v_accvgpr_read_b32 v118, a246
    v_accvgpr_read_b32 v119, a247
    v_accvgpr_read_b32 v120, a248
    v_accvgpr_read_b32 v121, a249
    v_accvgpr_read_b32 v122, a250
    v_accvgpr_read_b32 v123, a251
    v_accvgpr_read_b32 v124, a252
    v_accvgpr_read_b32 v125, a253
    v_accvgpr_read_b32 v126, a254
    v_accvgpr_read_b32 v127, a255
    v_pk_mul_f32 v[112:113], v[112:113], v[24:25] op_sel:[0,1] op_sel_hi:[1,1]
    v_pk_mul_f32 v[114:115], v[114:115], v[24:25] op_sel:[0,1] op_sel_hi:[1,1]
    v_pk_mul_f32 v[116:117], v[116:117], v[24:25] op_sel:[0,1] op_sel_hi:[1,1]
    v_pk_mul_f32 v[118:119], v[118:119], v[24:25] op_sel:[0,1] op_sel_hi:[1,1]
    v_pk_mul_f32 v[120:121], v[120:121], v[24:25] op_sel:[0,1] op_sel_hi:[1,1]
    v_pk_mul_f32 v[122:123], v[122:123], v[24:25] op_sel:[0,1] op_sel_hi:[1,1]
    v_pk_mul_f32 v[124:125], v[124:125], v[24:25] op_sel:[0,1] op_sel_hi:[1,1]
    v_pk_mul_f32 v[126:127], v[126:127], v[24:25] op_sel:[0,1] op_sel_hi:[1,1]
    v_cvt_pk_bf16_f32 v112, v112, v113
    v_cvt_pk_bf16_f32 v113, v114, v115
    v_cvt_pk_bf16_f32 v114, v116, v117
    v_cvt_pk_bf16_f32 v115, v118, v119
    v_cvt_pk_bf16_f32 v116, v120, v121
    v_cvt_pk_bf16_f32 v117, v122, v123
    v_cvt_pk_bf16_f32 v118, v124, v125
    v_cvt_pk_bf16_f32 v119, v126, v127
    ds_write_b64 v108, v[112:113] offset:4096
    ds_write_b64 v109, v[114:115] offset:4096
    ds_write_b64 v110, v[116:117] offset:4096
    ds_write_b64 v111, v[118:119] offset:4096
    s_add_u32 s32, s29, 0x180
    s_waitcnt lgkmcnt(4)
    buffer_store_dwordx4 v[128:131], v26, s[20:23], s32 offen offset:0
    s_add_u32 s32, s29, 0x1180
    buffer_store_dwordx4 v[132:135], v26, s[20:23], s32 offen offset:0
    s_add_u32 s32, s29, 0x2180
    buffer_store_dwordx4 v[136:139], v26, s[20:23], s32 offen offset:0
    s_add_u32 s32, s29, 0x3180
    buffer_store_dwordx4 v[140:143], v26, s[20:23], s32 offen offset:0
    s_waitcnt lgkmcnt(0)
    ds_read_b128 v[144:147], v23 offset:4096
    ds_read_b128 v[148:151], v23 offset:5120
    ds_read_b128 v[152:155], v23 offset:6144
    ds_read_b128 v[156:159], v23 offset:7168
    s_add_u32 s32, s29, 0x4180
    s_waitcnt lgkmcnt(0)
    buffer_store_dwordx4 v[144:147], v26, s[20:23], s32 offen offset:0
    s_add_u32 s32, s29, 0x5180
    buffer_store_dwordx4 v[148:151], v26, s[20:23], s32 offen offset:0
    s_add_u32 s32, s29, 0x6180
    buffer_store_dwordx4 v[152:155], v26, s[20:23], s32 offen offset:0
    s_add_u32 s32, s29, 0x7180
    buffer_store_dwordx4 v[156:159], v26, s[20:23], s32 offen offset:0
L_end:
    s_endpgm
L_slow_0:
    s_nop 15
    v_max3_f32 v27, v32, v33, v34
    v_max3_f32 v27, v27, v35, v36
    v_max3_f32 v27, v27, v37, v38
    v_max3_f32 v27, v27, v39, v40
    v_max3_f32 v27, v27, v41, v42
    v_max3_f32 v27, v27, v43, v44
    v_max3_f32 v27, v27, v45, v46
    v_max_f32 v27, v27, v47
    v_mov_b32 v28, v27
    s_nop 1
    v_permlane32_swap_b32 v27, v28
    s_nop 1
    v_max3_f32 v27, v27, v28, 0
    v_exp_f32 v29, -v27
    v_add_f32 v18, v18, v27
    v_sub_f32 v32, v32, v27
    v_sub_f32 v33, v33, v27
    v_sub_f32 v34, v34, v27
    v_sub_f32 v35, v35, v27
    v_sub_f32 v36, v36, v27
    v_sub_f32 v37, v37, v27
    v_sub_f32 v38, v38, v27
    v_sub_f32 v39, v39, v27
    v_sub_f32 v40, v40, v27
    v_sub_f32 v41, v41, v27
    v_sub_f32 v42, v42, v27
    v_sub_f32 v43, v43, v27
    v_sub_f32 v44, v44, v27
    v_sub_f32 v45, v45, v27
    v_sub_f32 v46, v46, v27
    v_sub_f32 v47, v47, v27
    v_mul_f32 v20, v20, v29
    v_mul_f32 v96, v96, v29
    v_mul_f32 v97, v97, v29
    v_mul_f32 v98, v98, v29
    v_mul_f32 v99, v99, v29
    v_mul_f32 v100, v100, v29
    v_mul_f32 v101, v101, v29
    v_mul_f32 v102, v102, v29
    v_mul_f32 v103, v103, v29
    v_mul_f32 v104, v104, v29
    v_mul_f32 v105, v105, v29
    v_mul_f32 v106, v106, v29
    v_mul_f32 v107, v107, v29
    v_mul_f32 v108, v108, v29
    v_mul_f32 v109, v109, v29
    v_mul_f32 v110, v110, v29
    v_mul_f32 v111, v111, v29
    v_mul_f32 v128, v128, v29
    v_mul_f32 v129, v129, v29
    v_mul_f32 v130, v130, v29
    v_mul_f32 v131, v131, v29
    v_mul_f32 v132, v132, v29
    v_mul_f32 v133, v133, v29
    v_mul_f32 v134, v134, v29
    v_mul_f32 v135, v135, v29
    v_mul_f32 v136, v136, v29
    v_mul_f32 v137, v137, v29
    v_mul_f32 v138, v138, v29
    v_mul_f32 v139, v139, v29
    v_mul_f32 v140, v140, v29
    v_mul_f32 v141, v141, v29
    v_mul_f32 v142, v142, v29
    v_mul_f32 v143, v143, v29
    v_mul_f32 v160, v160, v29
    v_mul_f32 v161, v161, v29
    v_mul_f32 v162, v162, v29
    v_mul_f32 v163, v163, v29
    v_mul_f32 v164, v164, v29
    v_mul_f32 v165, v165, v29
    v_mul_f32 v166, v166, v29
    v_mul_f32 v167, v167, v29
    v_mul_f32 v168, v168, v29
    v_mul_f32 v169, v169, v29
    v_mul_f32 v170, v170, v29
    v_mul_f32 v171, v171, v29
    v_mul_f32 v172, v172, v29
    v_mul_f32 v173, v173, v29
    v_mul_f32 v174, v174, v29
    v_mul_f32 v175, v175, v29
    v_mul_f32 v192, v192, v29
    v_mul_f32 v193, v193, v29
    v_mul_f32 v194, v194, v29
    v_mul_f32 v195, v195, v29
    v_mul_f32 v196, v196, v29
    v_mul_f32 v197, v197, v29
    v_mul_f32 v198, v198, v29
    v_mul_f32 v199, v199, v29
    v_mul_f32 v200, v200, v29
    v_mul_f32 v201, v201, v29
    v_mul_f32 v202, v202, v29
    v_mul_f32 v203, v203, v29
    v_mul_f32 v204, v204, v29
    v_mul_f32 v205, v205, v29
    v_mul_f32 v206, v206, v29
    v_mul_f32 v207, v207, v29
    v_mul_f32 v224, v224, v29
    v_mul_f32 v225, v225, v29
    v_mul_f32 v226, v226, v29
    v_mul_f32 v227, v227, v29
    v_mul_f32 v228, v228, v29
    v_mul_f32 v229, v229, v29
    v_mul_f32 v230, v230, v29
    v_mul_f32 v231, v231, v29
    v_mul_f32 v232, v232, v29
    v_mul_f32 v233, v233, v29
    v_mul_f32 v234, v234, v29
    v_mul_f32 v235, v235, v29
    v_mul_f32 v236, v236, v29
    v_mul_f32 v237, v237, v29
    v_mul_f32 v238, v238, v29
    v_mul_f32 v239, v239, v29
    v_accvgpr_read_b32 v27, a160
    v_mul_f32 v27, v27, v29
    v_accvgpr_write_b32 a160, v27
    v_accvgpr_read_b32 v28, a161
    v_mul_f32 v28, v28, v29
    v_accvgpr_write_b32 a161, v28
    v_accvgpr_read_b32 v27, a162
    v_mul_f32 v27, v27, v29
    v_accvgpr_write_b32 a162, v27
    v_accvgpr_read_b32 v28, a163
    v_mul_f32 v28, v28, v29
    v_accvgpr_write_b32 a163, v28
    v_accvgpr_read_b32 v27, a164
    v_mul_f32 v27, v27, v29
    v_accvgpr_write_b32 a164, v27
    v_accvgpr_read_b32 v28, a165
    v_mul_f32 v28, v28, v29
    v_accvgpr_write_b32 a165, v28
    v_accvgpr_read_b32 v27, a166
    v_mul_f32 v27, v27, v29
    v_accvgpr_write_b32 a166, v27
    v_accvgpr_read_b32 v28, a167
    v_mul_f32 v28, v28, v29
    v_accvgpr_write_b32 a167, v28
    v_accvgpr_read_b32 v27, a168
    v_mul_f32 v27, v27, v29
    v_accvgpr_write_b32 a168, v27
    v_accvgpr_read_b32 v28, a169
    v_mul_f32 v28, v28, v29
    v_accvgpr_write_b32 a169, v28
    v_accvgpr_read_b32 v27, a170
    v_mul_f32 v27, v27, v29
    v_accvgpr_write_b32 a170, v27
    v_accvgpr_read_b32 v28, a171
    v_mul_f32 v28, v28, v29
    v_accvgpr_write_b32 a171, v28
    v_accvgpr_read_b32 v27, a172
    v_mul_f32 v27, v27, v29
    v_accvgpr_write_b32 a172, v27
    v_accvgpr_read_b32 v28, a173
    v_mul_f32 v28, v28, v29
    v_accvgpr_write_b32 a173, v28
    v_accvgpr_read_b32 v27, a174
    v_mul_f32 v27, v27, v29
    v_accvgpr_write_b32 a174, v27
    v_accvgpr_read_b32 v28, a175
    v_mul_f32 v28, v28, v29
    v_accvgpr_write_b32 a175, v28
    v_accvgpr_read_b32 v27, a192
    v_mul_f32 v27, v27, v29
    v_accvgpr_write_b32 a192, v27
    v_accvgpr_read_b32 v28, a193
    v_mul_f32 v28, v28, v29
    v_accvgpr_write_b32 a193, v28
    v_accvgpr_read_b32 v27, a194
    v_mul_f32 v27, v27, v29
    v_accvgpr_write_b32 a194, v27
    v_accvgpr_read_b32 v28, a195
    v_mul_f32 v28, v28, v29
    v_accvgpr_write_b32 a195, v28
    v_accvgpr_read_b32 v27, a196
    v_mul_f32 v27, v27, v29
    v_accvgpr_write_b32 a196, v27
    v_accvgpr_read_b32 v28, a197
    v_mul_f32 v28, v28, v29
    v_accvgpr_write_b32 a197, v28
    v_accvgpr_read_b32 v27, a198
    v_mul_f32 v27, v27, v29
    v_accvgpr_write_b32 a198, v27
    v_accvgpr_read_b32 v28, a199
    v_mul_f32 v28, v28, v29
    v_accvgpr_write_b32 a199, v28
    v_accvgpr_read_b32 v27, a200
    v_mul_f32 v27, v27, v29
    v_accvgpr_write_b32 a200, v27
    v_accvgpr_read_b32 v28, a201
    v_mul_f32 v28, v28, v29
    v_accvgpr_write_b32 a201, v28
    v_accvgpr_read_b32 v27, a202
    v_mul_f32 v27, v27, v29
    v_accvgpr_write_b32 a202, v27
    v_accvgpr_read_b32 v28, a203
    v_mul_f32 v28, v28, v29
    v_accvgpr_write_b32 a203, v28
    v_accvgpr_read_b32 v27, a204
    v_mul_f32 v27, v27, v29
    v_accvgpr_write_b32 a204, v27
    v_accvgpr_read_b32 v28, a205
    v_mul_f32 v28, v28, v29
    v_accvgpr_write_b32 a205, v28
    v_accvgpr_read_b32 v27, a206
    v_mul_f32 v27, v27, v29
    v_accvgpr_write_b32 a206, v27
    v_accvgpr_read_b32 v28, a207
    v_mul_f32 v28, v28, v29
    v_accvgpr_write_b32 a207, v28
    v_accvgpr_read_b32 v27, a224
    v_mul_f32 v27, v27, v29
    v_accvgpr_write_b32 a224, v27
    v_accvgpr_read_b32 v28, a225
    v_mul_f32 v28, v28, v29
    v_accvgpr_write_b32 a225, v28
    v_accvgpr_read_b32 v27, a226
    v_mul_f32 v27, v27, v29
    v_accvgpr_write_b32 a226, v27
    v_accvgpr_read_b32 v28, a227
    v_mul_f32 v28, v28, v29
    v_accvgpr_write_b32 a227, v28
    v_accvgpr_read_b32 v27, a228
    v_mul_f32 v27, v27, v29
    v_accvgpr_write_b32 a228, v27
    v_accvgpr_read_b32 v28, a229
    v_mul_f32 v28, v28, v29
    v_accvgpr_write_b32 a229, v28
    v_accvgpr_read_b32 v27, a230
    v_mul_f32 v27, v27, v29
    v_accvgpr_write_b32 a230, v27
    v_accvgpr_read_b32 v28, a231
    v_mul_f32 v28, v28, v29
    v_accvgpr_write_b32 a231, v28
    v_accvgpr_read_b32 v27, a232
    v_mul_f32 v27, v27, v29
    v_accvgpr_write_b32 a232, v27
    v_accvgpr_read_b32 v28, a233
    v_mul_f32 v28, v28, v29
    v_accvgpr_write_b32 a233, v28
    v_accvgpr_read_b32 v27, a234
    v_mul_f32 v27, v27, v29
    v_accvgpr_write_b32 a234, v27
    v_accvgpr_read_b32 v28, a235
    v_mul_f32 v28, v28, v29
    v_accvgpr_write_b32 a235, v28
    v_accvgpr_read_b32 v27, a236
    v_mul_f32 v27, v27, v29
    v_accvgpr_write_b32 a236, v27
    v_accvgpr_read_b32 v28, a237
    v_mul_f32 v28, v28, v29
    v_accvgpr_write_b32 a237, v28
    v_accvgpr_read_b32 v27, a238
    v_mul_f32 v27, v27, v29
    v_accvgpr_write_b32 a238, v27
    v_accvgpr_read_b32 v28, a239
    v_mul_f32 v28, v28, v29
    v_accvgpr_write_b32 a239, v28
    v_max3_f32 v27, v48, v49, v50
    v_max3_f32 v27, v27, v51, v52
    v_max3_f32 v27, v27, v53, v54
    v_max3_f32 v27, v27, v55, v56
    v_max3_f32 v27, v27, v57, v58
    v_max3_f32 v27, v27, v59, v60
    v_max3_f32 v27, v27, v61, v62
    v_max_f32 v27, v27, v63
    v_mov_b32 v28, v27
    s_nop 1
    v_permlane32_swap_b32 v27, v28
    s_nop 1
    v_max3_f32 v27, v27, v28, 0
    v_exp_f32 v29, -v27
    v_add_f32 v19, v19, v27
    v_sub_f32 v48, v48, v27
    v_sub_f32 v49, v49, v27
    v_sub_f32 v50, v50, v27
    v_sub_f32 v51, v51, v27
    v_sub_f32 v52, v52, v27
    v_sub_f32 v53, v53, v27
    v_sub_f32 v54, v54, v27
    v_sub_f32 v55, v55, v27
    v_sub_f32 v56, v56, v27
    v_sub_f32 v57, v57, v27
    v_sub_f32 v58, v58, v27
    v_sub_f32 v59, v59, v27
    v_sub_f32 v60, v60, v27
    v_sub_f32 v61, v61, v27
    v_sub_f32 v62, v62, v27
    v_sub_f32 v63, v63, v27
    v_mul_f32 v21, v21, v29
    v_mul_f32 v112, v112, v29
    v_mul_f32 v113, v113, v29
    v_mul_f32 v114, v114, v29
    v_mul_f32 v115, v115, v29
    v_mul_f32 v116, v116, v29
    v_mul_f32 v117, v117, v29
    v_mul_f32 v118, v118, v29
    v_mul_f32 v119, v119, v29
    v_mul_f32 v120, v120, v29
    v_mul_f32 v121, v121, v29
    v_mul_f32 v122, v122, v29
    v_mul_f32 v123, v123, v29
    v_mul_f32 v124, v124, v29
    v_mul_f32 v125, v125, v29
    v_mul_f32 v126, v126, v29
    v_mul_f32 v127, v127, v29
    v_mul_f32 v144, v144, v29
    v_mul_f32 v145, v145, v29
    v_mul_f32 v146, v146, v29
    v_mul_f32 v147, v147, v29
    v_mul_f32 v148, v148, v29
    v_mul_f32 v149, v149, v29
    v_mul_f32 v150, v150, v29
    v_mul_f32 v151, v151, v29
    v_mul_f32 v152, v152, v29
    v_mul_f32 v153, v153, v29
    v_mul_f32 v154, v154, v29
    v_mul_f32 v155, v155, v29
    v_mul_f32 v156, v156, v29
    v_mul_f32 v157, v157, v29
    v_mul_f32 v158, v158, v29
    v_mul_f32 v159, v159, v29
    v_mul_f32 v176, v176, v29
    v_mul_f32 v177, v177, v29
    v_mul_f32 v178, v178, v29
    v_mul_f32 v179, v179, v29
    v_mul_f32 v180, v180, v29
    v_mul_f32 v181, v181, v29
    v_mul_f32 v182, v182, v29
    v_mul_f32 v183, v183, v29
    v_mul_f32 v184, v184, v29
    v_mul_f32 v185, v185, v29
    v_mul_f32 v186, v186, v29
    v_mul_f32 v187, v187, v29
    v_mul_f32 v188, v188, v29
    v_mul_f32 v189, v189, v29
    v_mul_f32 v190, v190, v29
    v_mul_f32 v191, v191, v29
    v_mul_f32 v208, v208, v29
    v_mul_f32 v209, v209, v29
    v_mul_f32 v210, v210, v29
    v_mul_f32 v211, v211, v29
    v_mul_f32 v212, v212, v29
    v_mul_f32 v213, v213, v29
    v_mul_f32 v214, v214, v29
    v_mul_f32 v215, v215, v29
    v_mul_f32 v216, v216, v29
    v_mul_f32 v217, v217, v29
    v_mul_f32 v218, v218, v29
    v_mul_f32 v219, v219, v29
    v_mul_f32 v220, v220, v29
    v_mul_f32 v221, v221, v29
    v_mul_f32 v222, v222, v29
    v_mul_f32 v223, v223, v29
    v_mul_f32 v240, v240, v29
    v_mul_f32 v241, v241, v29
    v_mul_f32 v242, v242, v29
    v_mul_f32 v243, v243, v29
    v_mul_f32 v244, v244, v29
    v_mul_f32 v245, v245, v29
    v_mul_f32 v246, v246, v29
    v_mul_f32 v247, v247, v29
    v_mul_f32 v248, v248, v29
    v_mul_f32 v249, v249, v29
    v_mul_f32 v250, v250, v29
    v_mul_f32 v251, v251, v29
    v_mul_f32 v252, v252, v29
    v_mul_f32 v253, v253, v29
    v_mul_f32 v254, v254, v29
    v_mul_f32 v255, v255, v29
    v_accvgpr_read_b32 v27, a176
    v_mul_f32 v27, v27, v29
    v_accvgpr_write_b32 a176, v27
    v_accvgpr_read_b32 v28, a177
    v_mul_f32 v28, v28, v29
    v_accvgpr_write_b32 a177, v28
    v_accvgpr_read_b32 v27, a178
    v_mul_f32 v27, v27, v29
    v_accvgpr_write_b32 a178, v27
    v_accvgpr_read_b32 v28, a179
    v_mul_f32 v28, v28, v29
    v_accvgpr_write_b32 a179, v28
    v_accvgpr_read_b32 v27, a180
    v_mul_f32 v27, v27, v29
    v_accvgpr_write_b32 a180, v27
    v_accvgpr_read_b32 v28, a181
    v_mul_f32 v28, v28, v29
    v_accvgpr_write_b32 a181, v28
    v_accvgpr_read_b32 v27, a182
    v_mul_f32 v27, v27, v29
    v_accvgpr_write_b32 a182, v27
    v_accvgpr_read_b32 v28, a183
    v_mul_f32 v28, v28, v29
    v_accvgpr_write_b32 a183, v28
    v_accvgpr_read_b32 v27, a184
    v_mul_f32 v27, v27, v29
    v_accvgpr_write_b32 a184, v27
    v_accvgpr_read_b32 v28, a185
    v_mul_f32 v28, v28, v29
    v_accvgpr_write_b32 a185, v28
    v_accvgpr_read_b32 v27, a186
    v_mul_f32 v27, v27, v29
    v_accvgpr_write_b32 a186, v27
    v_accvgpr_read_b32 v28, a187
    v_mul_f32 v28, v28, v29
    v_accvgpr_write_b32 a187, v28
    v_accvgpr_read_b32 v27, a188
    v_mul_f32 v27, v27, v29
    v_accvgpr_write_b32 a188, v27
    v_accvgpr_read_b32 v28, a189
    v_mul_f32 v28, v28, v29
    v_accvgpr_write_b32 a189, v28
    v_accvgpr_read_b32 v27, a190
    v_mul_f32 v27, v27, v29
    v_accvgpr_write_b32 a190, v27
    v_accvgpr_read_b32 v28, a191
    v_mul_f32 v28, v28, v29
    v_accvgpr_write_b32 a191, v28
    v_accvgpr_read_b32 v27, a208
    v_mul_f32 v27, v27, v29
    v_accvgpr_write_b32 a208, v27
    v_accvgpr_read_b32 v28, a209
    v_mul_f32 v28, v28, v29
    v_accvgpr_write_b32 a209, v28
    v_accvgpr_read_b32 v27, a210
    v_mul_f32 v27, v27, v29
    v_accvgpr_write_b32 a210, v27
    v_accvgpr_read_b32 v28, a211
    v_mul_f32 v28, v28, v29
    v_accvgpr_write_b32 a211, v28
    v_accvgpr_read_b32 v27, a212
    v_mul_f32 v27, v27, v29
    v_accvgpr_write_b32 a212, v27
    v_accvgpr_read_b32 v28, a213
    v_mul_f32 v28, v28, v29
    v_accvgpr_write_b32 a213, v28
    v_accvgpr_read_b32 v27, a214
    v_mul_f32 v27, v27, v29
    v_accvgpr_write_b32 a214, v27
    v_accvgpr_read_b32 v28, a215
    v_mul_f32 v28, v28, v29
    v_accvgpr_write_b32 a215, v28
    v_accvgpr_read_b32 v27, a216
    v_mul_f32 v27, v27, v29
    v_accvgpr_write_b32 a216, v27
    v_accvgpr_read_b32 v28, a217
    v_mul_f32 v28, v28, v29
    v_accvgpr_write_b32 a217, v28
    v_accvgpr_read_b32 v27, a218
    v_mul_f32 v27, v27, v29
    v_accvgpr_write_b32 a218, v27
    v_accvgpr_read_b32 v28, a219
    v_mul_f32 v28, v28, v29
    v_accvgpr_write_b32 a219, v28
    v_accvgpr_read_b32 v27, a220
    v_mul_f32 v27, v27, v29
    v_accvgpr_write_b32 a220, v27
    v_accvgpr_read_b32 v28, a221
    v_mul_f32 v28, v28, v29
    v_accvgpr_write_b32 a221, v28
    v_accvgpr_read_b32 v27, a222
    v_mul_f32 v27, v27, v29
    v_accvgpr_write_b32 a222, v27
    v_accvgpr_read_b32 v28, a223
    v_mul_f32 v28, v28, v29
    v_accvgpr_write_b32 a223, v28
    v_accvgpr_read_b32 v27, a240
    v_mul_f32 v27, v27, v29
    v_accvgpr_write_b32 a240, v27
    v_accvgpr_read_b32 v28, a241
    v_mul_f32 v28, v28, v29
    v_accvgpr_write_b32 a241, v28
    v_accvgpr_read_b32 v27, a242
    v_mul_f32 v27, v27, v29
    v_accvgpr_write_b32 a242, v27
    v_accvgpr_read_b32 v28, a243
    v_mul_f32 v28, v28, v29
    v_accvgpr_write_b32 a243, v28
    v_accvgpr_read_b32 v27, a244
    v_mul_f32 v27, v27, v29
    v_accvgpr_write_b32 a244, v27
    v_accvgpr_read_b32 v28, a245
    v_mul_f32 v28, v28, v29
    v_accvgpr_write_b32 a245, v28
    v_accvgpr_read_b32 v27, a246
    v_mul_f32 v27, v27, v29
    v_accvgpr_write_b32 a246, v27
    v_accvgpr_read_b32 v28, a247
    v_mul_f32 v28, v28, v29
    v_accvgpr_write_b32 a247, v28
    v_accvgpr_read_b32 v27, a248
    v_mul_f32 v27, v27, v29
    v_accvgpr_write_b32 a248, v27
    v_accvgpr_read_b32 v28, a249
    v_mul_f32 v28, v28, v29
    v_accvgpr_write_b32 a249, v28
    v_accvgpr_read_b32 v27, a250
    v_mul_f32 v27, v27, v29
    v_accvgpr_write_b32 a250, v27
    v_accvgpr_read_b32 v28, a251
    v_mul_f32 v28, v28, v29
    v_accvgpr_write_b32 a251, v28
    v_accvgpr_read_b32 v27, a252
    v_mul_f32 v27, v27, v29
    v_accvgpr_write_b32 a252, v27
    v_accvgpr_read_b32 v28, a253
    v_mul_f32 v28, v28, v29
    v_accvgpr_write_b32 a253, v28
    v_accvgpr_read_b32 v27, a254
    v_mul_f32 v27, v27, v29
    v_accvgpr_write_b32 a254, v27
    v_accvgpr_read_b32 v28, a255
    v_mul_f32 v28, v28, v29
    v_accvgpr_write_b32 a255, v28
    s_nop 1
    s_setpc_b64 s[40:41]
L_slow_1:
    s_nop 15
    v_max3_f32 v27, v64, v65, v66
    v_max3_f32 v27, v27, v67, v68
    v_max3_f32 v27, v27, v69, v70
    v_max3_f32 v27, v27, v71, v72
    v_max3_f32 v27, v27, v73, v74
    v_max3_f32 v27, v27, v75, v76
    v_max3_f32 v27, v27, v77, v78
    v_max_f32 v27, v27, v79
    v_mov_b32 v28, v27
    s_nop 1
    v_permlane32_swap_b32 v27, v28
    s_nop 1
    v_max3_f32 v27, v27, v28, 0
    v_exp_f32 v29, -v27
    v_add_f32 v18, v18, v27
    v_sub_f32 v64, v64, v27
    v_sub_f32 v65, v65, v27
    v_sub_f32 v66, v66, v27
    v_sub_f32 v67, v67, v27
    v_sub_f32 v68, v68, v27
    v_sub_f32 v69, v69, v27
    v_sub_f32 v70, v70, v27
    v_sub_f32 v71, v71, v27
    v_sub_f32 v72, v72, v27
    v_sub_f32 v73, v73, v27
    v_sub_f32 v74, v74, v27
    v_sub_f32 v75, v75, v27
    v_sub_f32 v76, v76, v27
    v_sub_f32 v77, v77, v27
    v_sub_f32 v78, v78, v27
    v_sub_f32 v79, v79, v27
    v_mul_f32 v20, v20, v29
    v_mul_f32 v96, v96, v29
    v_mul_f32 v97, v97, v29
    v_mul_f32 v98, v98, v29
    v_mul_f32 v99, v99, v29
    v_mul_f32 v100, v100, v29
    v_mul_f32 v101, v101, v29
    v_mul_f32 v102, v102, v29
    v_mul_f32 v103, v103, v29
    v_mul_f32 v104, v104, v29
    v_mul_f32 v105, v105, v29
    v_mul_f32 v106, v106, v29
    v_mul_f32 v107, v107, v29
    v_mul_f32 v108, v108, v29
    v_mul_f32 v109, v109, v29
    v_mul_f32 v110, v110, v29
    v_mul_f32 v111, v111, v29
    v_mul_f32 v128, v128, v29
    v_mul_f32 v129, v129, v29
    v_mul_f32 v130, v130, v29
    v_mul_f32 v131, v131, v29
    v_mul_f32 v132, v132, v29
    v_mul_f32 v133, v133, v29
    v_mul_f32 v134, v134, v29
    v_mul_f32 v135, v135, v29
    v_mul_f32 v136, v136, v29
    v_mul_f32 v137, v137, v29
    v_mul_f32 v138, v138, v29
    v_mul_f32 v139, v139, v29
    v_mul_f32 v140, v140, v29
    v_mul_f32 v141, v141, v29
    v_mul_f32 v142, v142, v29
    v_mul_f32 v143, v143, v29
    v_mul_f32 v160, v160, v29
    v_mul_f32 v161, v161, v29
    v_mul_f32 v162, v162, v29
    v_mul_f32 v163, v163, v29
    v_mul_f32 v164, v164, v29
    v_mul_f32 v165, v165, v29
    v_mul_f32 v166, v166, v29
    v_mul_f32 v167, v167, v29
    v_mul_f32 v168, v168, v29
    v_mul_f32 v169, v169, v29
    v_mul_f32 v170, v170, v29
    v_mul_f32 v171, v171, v29
    v_mul_f32 v172, v172, v29
    v_mul_f32 v173, v173, v29
    v_mul_f32 v174, v174, v29
    v_mul_f32 v175, v175, v29
    v_mul_f32 v192, v192, v29
    v_mul_f32 v193, v193, v29
    v_mul_f32 v194, v194, v29
    v_mul_f32 v195, v195, v29
    v_mul_f32 v196, v196, v29
    v_mul_f32 v197, v197, v29
    v_mul_f32 v198, v198, v29
    v_mul_f32 v199, v199, v29
    v_mul_f32 v200, v200, v29
    v_mul_f32 v201, v201, v29
    v_mul_f32 v202, v202, v29
    v_mul_f32 v203, v203, v29
    v_mul_f32 v204, v204, v29
    v_mul_f32 v205, v205, v29
    v_mul_f32 v206, v206, v29
    v_mul_f32 v207, v207, v29
    v_mul_f32 v224, v224, v29
    v_mul_f32 v225, v225, v29
    v_mul_f32 v226, v226, v29
    v_mul_f32 v227, v227, v29
    v_mul_f32 v228, v228, v29
    v_mul_f32 v229, v229, v29
    v_mul_f32 v230, v230, v29
    v_mul_f32 v231, v231, v29
    v_mul_f32 v232, v232, v29
    v_mul_f32 v233, v233, v29
    v_mul_f32 v234, v234, v29
    v_mul_f32 v235, v235, v29
    v_mul_f32 v236, v236, v29
    v_mul_f32 v237, v237, v29
    v_mul_f32 v238, v238, v29
    v_mul_f32 v239, v239, v29
    v_accvgpr_read_b32 v27, a160
    v_mul_f32 v27, v27, v29
    v_accvgpr_write_b32 a160, v27
    v_accvgpr_read_b32 v28, a161
    v_mul_f32 v28, v28, v29
    v_accvgpr_write_b32 a161, v28
    v_accvgpr_read_b32 v27, a162
    v_mul_f32 v27, v27, v29
    v_accvgpr_write_b32 a162, v27
    v_accvgpr_read_b32 v28, a163
    v_mul_f32 v28, v28, v29
    v_accvgpr_write_b32 a163, v28
    v_accvgpr_read_b32 v27, a164
    v_mul_f32 v27, v27, v29
    v_accvgpr_write_b32 a164, v27
    v_accvgpr_read_b32 v28, a165
    v_mul_f32 v28, v28, v29
    v_accvgpr_write_b32 a165, v28
    v_accvgpr_read_b32 v27, a166
    v_mul_f32 v27, v27, v29
    v_accvgpr_write_b32 a166, v27
    v_accvgpr_read_b32 v28, a167
    v_mul_f32 v28, v28, v29
    v_accvgpr_write_b32 a167, v28
    v_accvgpr_read_b32 v27, a168
    v_mul_f32 v27, v27, v29
    v_accvgpr_write_b32 a168, v27
    v_accvgpr_read_b32 v28, a169
    v_mul_f32 v28, v28, v29
    v_accvgpr_write_b32 a169, v28
    v_accvgpr_read_b32 v27, a170
    v_mul_f32 v27, v27, v29
    v_accvgpr_write_b32 a170, v27
    v_accvgpr_read_b32 v28, a171
    v_mul_f32 v28, v28, v29
    v_accvgpr_write_b32 a171, v28
    v_accvgpr_read_b32 v27, a172
    v_mul_f32 v27, v27, v29
    v_accvgpr_write_b32 a172, v27
    v_accvgpr_read_b32 v28, a173
    v_mul_f32 v28, v28, v29
    v_accvgpr_write_b32 a173, v28
    v_accvgpr_read_b32 v27, a174
    v_mul_f32 v27, v27, v29
    v_accvgpr_write_b32 a174, v27
    v_accvgpr_read_b32 v28, a175
    v_mul_f32 v28, v28, v29
    v_accvgpr_write_b32 a175, v28
    v_accvgpr_read_b32 v27, a192
    v_mul_f32 v27, v27, v29
    v_accvgpr_write_b32 a192, v27
    v_accvgpr_read_b32 v28, a193
    v_mul_f32 v28, v28, v29
    v_accvgpr_write_b32 a193, v28
    v_accvgpr_read_b32 v27, a194
    v_mul_f32 v27, v27, v29
    v_accvgpr_write_b32 a194, v27
    v_accvgpr_read_b32 v28, a195
    v_mul_f32 v28, v28, v29
    v_accvgpr_write_b32 a195, v28
    v_accvgpr_read_b32 v27, a196
    v_mul_f32 v27, v27, v29
    v_accvgpr_write_b32 a196, v27
    v_accvgpr_read_b32 v28, a197
    v_mul_f32 v28, v28, v29
    v_accvgpr_write_b32 a197, v28
    v_accvgpr_read_b32 v27, a198
    v_mul_f32 v27, v27, v29
    v_accvgpr_write_b32 a198, v27
    v_accvgpr_read_b32 v28, a199
    v_mul_f32 v28, v28, v29
    v_accvgpr_write_b32 a199, v28
    v_accvgpr_read_b32 v27, a200
    v_mul_f32 v27, v27, v29
    v_accvgpr_write_b32 a200, v27
    v_accvgpr_read_b32 v28, a201
    v_mul_f32 v28, v28, v29
    v_accvgpr_write_b32 a201, v28
    v_accvgpr_read_b32 v27, a202
    v_mul_f32 v27, v27, v29
    v_accvgpr_write_b32 a202, v27
    v_accvgpr_read_b32 v28, a203
    v_mul_f32 v28, v28, v29
    v_accvgpr_write_b32 a203, v28
    v_accvgpr_read_b32 v27, a204
    v_mul_f32 v27, v27, v29
    v_accvgpr_write_b32 a204, v27
    v_accvgpr_read_b32 v28, a205
    v_mul_f32 v28, v28, v29
    v_accvgpr_write_b32 a205, v28
    v_accvgpr_read_b32 v27, a206
    v_mul_f32 v27, v27, v29
    v_accvgpr_write_b32 a206, v27
    v_accvgpr_read_b32 v28, a207
    v_mul_f32 v28, v28, v29
    v_accvgpr_write_b32 a207, v28
    v_accvgpr_read_b32 v27, a224
    v_mul_f32 v27, v27, v29
    v_accvgpr_write_b32 a224, v27
    v_accvgpr_read_b32 v28, a225
    v_mul_f32 v28, v28, v29
    v_accvgpr_write_b32 a225, v28
    v_accvgpr_read_b32 v27, a226
    v_mul_f32 v27, v27, v29
    v_accvgpr_write_b32 a226, v27
    v_accvgpr_read_b32 v28, a227
    v_mul_f32 v28, v28, v29
    v_accvgpr_write_b32 a227, v28
    v_accvgpr_read_b32 v27, a228
    v_mul_f32 v27, v27, v29
    v_accvgpr_write_b32 a228, v27
    v_accvgpr_read_b32 v28, a229
    v_mul_f32 v28, v28, v29
    v_accvgpr_write_b32 a229, v28
    v_accvgpr_read_b32 v27, a230
    v_mul_f32 v27, v27, v29
    v_accvgpr_write_b32 a230, v27
    v_accvgpr_read_b32 v28, a231
    v_mul_f32 v28, v28, v29
    v_accvgpr_write_b32 a231, v28
    v_accvgpr_read_b32 v27, a232
    v_mul_f32 v27, v27, v29
    v_accvgpr_write_b32 a232, v27
    v_accvgpr_read_b32 v28, a233
    v_mul_f32 v28, v28, v29
    v_accvgpr_write_b32 a233, v28
    v_accvgpr_read_b32 v27, a234
    v_mul_f32 v27, v27, v29
    v_accvgpr_write_b32 a234, v27
    v_accvgpr_read_b32 v28, a235
    v_mul_f32 v28, v28, v29
    v_accvgpr_write_b32 a235, v28
    v_accvgpr_read_b32 v27, a236
    v_mul_f32 v27, v27, v29
    v_accvgpr_write_b32 a236, v27
    v_accvgpr_read_b32 v28, a237
    v_mul_f32 v28, v28, v29
    v_accvgpr_write_b32 a237, v28
    v_accvgpr_read_b32 v27, a238
    v_mul_f32 v27, v27, v29
    v_accvgpr_write_b32 a238, v27
    v_accvgpr_read_b32 v28, a239
    v_mul_f32 v28, v28, v29
    v_accvgpr_write_b32 a239, v28
    v_max3_f32 v27, v80, v81, v82
    v_max3_f32 v27, v27, v83, v84
    v_max3_f32 v27, v27, v85, v86
    v_max3_f32 v27, v27, v87, v88
    v_max3_f32 v27, v27, v89, v90
    v_max3_f32 v27, v27, v91, v92
    v_max3_f32 v27, v27, v93, v94
    v_max_f32 v27, v27, v95
    v_mov_b32 v28, v27
    s_nop 1
    v_permlane32_swap_b32 v27, v28
    s_nop 1
    v_max3_f32 v27, v27, v28, 0
    v_exp_f32 v29, -v27
    v_add_f32 v19, v19, v27
    v_sub_f32 v80, v80, v27
    v_sub_f32 v81, v81, v27
    v_sub_f32 v82, v82, v27
    v_sub_f32 v83, v83, v27
    v_sub_f32 v84, v84, v27
    v_sub_f32 v85, v85, v27
    v_sub_f32 v86, v86, v27
    v_sub_f32 v87, v87, v27
    v_sub_f32 v88, v88, v27
    v_sub_f32 v89, v89, v27
    v_sub_f32 v90, v90, v27
    v_sub_f32 v91, v91, v27
    v_sub_f32 v92, v92, v27
    v_sub_f32 v93, v93, v27
    v_sub_f32 v94, v94, v27
    v_sub_f32 v95, v95, v27
    v_mul_f32 v21, v21, v29
    v_mul_f32 v112, v112, v29
    v_mul_f32 v113, v113, v29
    v_mul_f32 v114, v114, v29
    v_mul_f32 v115, v115, v29
    v_mul_f32 v116, v116, v29
    v_mul_f32 v117, v117, v29
    v_mul_f32 v118, v118, v29
    v_mul_f32 v119, v119, v29
    v_mul_f32 v120, v120, v29
    v_mul_f32 v121, v121, v29
    v_mul_f32 v122, v122, v29
    v_mul_f32 v123, v123, v29
    v_mul_f32 v124, v124, v29
    v_mul_f32 v125, v125, v29
    v_mul_f32 v126, v126, v29
    v_mul_f32 v127, v127, v29
    v_mul_f32 v144, v144, v29
    v_mul_f32 v145, v145, v29
    v_mul_f32 v146, v146, v29
    v_mul_f32 v147, v147, v29
    v_mul_f32 v148, v148, v29
    v_mul_f32 v149, v149, v29
    v_mul_f32 v150, v150, v29
    v_mul_f32 v151, v151, v29
    v_mul_f32 v152, v152, v29
    v_mul_f32 v153, v153, v29
    v_mul_f32 v154, v154, v29
    v_mul_f32 v155, v155, v29
    v_mul_f32 v156, v156, v29
    v_mul_f32 v157, v157, v29
    v_mul_f32 v158, v158, v29
    v_mul_f32 v159, v159, v29
    v_mul_f32 v176, v176, v29
    v_mul_f32 v177, v177, v29
    v_mul_f32 v178, v178, v29
    v_mul_f32 v179, v179, v29
    v_mul_f32 v180, v180, v29
    v_mul_f32 v181, v181, v29
    v_mul_f32 v182, v182, v29
    v_mul_f32 v183, v183, v29
    v_mul_f32 v184, v184, v29
    v_mul_f32 v185, v185, v29
    v_mul_f32 v186, v186, v29
    v_mul_f32 v187, v187, v29
    v_mul_f32 v188, v188, v29
    v_mul_f32 v189, v189, v29
    v_mul_f32 v190, v190, v29
    v_mul_f32 v191, v191, v29
    v_mul_f32 v208, v208, v29
    v_mul_f32 v209, v209, v29
    v_mul_f32 v210, v210, v29
    v_mul_f32 v211, v211, v29
    v_mul_f32 v212, v212, v29
    v_mul_f32 v213, v213, v29
    v_mul_f32 v214, v214, v29
    v_mul_f32 v215, v215, v29
    v_mul_f32 v216, v216, v29
    v_mul_f32 v217, v217, v29
    v_mul_f32 v218, v218, v29
    v_mul_f32 v219, v219, v29
    v_mul_f32 v220, v220, v29
    v_mul_f32 v221, v221, v29
    v_mul_f32 v222, v222, v29
    v_mul_f32 v223, v223, v29
    v_mul_f32 v240, v240, v29
    v_mul_f32 v241, v241, v29
    v_mul_f32 v242, v242, v29
    v_mul_f32 v243, v243, v29
    v_mul_f32 v244, v244, v29
    v_mul_f32 v245, v245, v29
    v_mul_f32 v246, v246, v29
    v_mul_f32 v247, v247, v29
    v_mul_f32 v248, v248, v29
    v_mul_f32 v249, v249, v29
    v_mul_f32 v250, v250, v29
    v_mul_f32 v251, v251, v29
    v_mul_f32 v252, v252, v29
    v_mul_f32 v253, v253, v29
    v_mul_f32 v254, v254, v29
    v_mul_f32 v255, v255, v29
    v_accvgpr_read_b32 v27, a176
    v_mul_f32 v27, v27, v29
    v_accvgpr_write_b32 a176, v27
    v_accvgpr_read_b32 v28, a177
    v_mul_f32 v28, v28, v29
    v_accvgpr_write_b32 a177, v28
    v_accvgpr_read_b32 v27, a178
    v_mul_f32 v27, v27, v29
    v_accvgpr_write_b32 a178, v27
    v_accvgpr_read_b32 v28, a179
    v_mul_f32 v28, v28, v29
    v_accvgpr_write_b32 a179, v28
    v_accvgpr_read_b32 v27, a180
    v_mul_f32 v27, v27, v29
    v_accvgpr_write_b32 a180, v27
    v_accvgpr_read_b32 v28, a181
    v_mul_f32 v28, v28, v29
    v_accvgpr_write_b32 a181, v28
    v_accvgpr_read_b32 v27, a182
    v_mul_f32 v27, v27, v29
    v_accvgpr_write_b32 a182, v27
    v_accvgpr_read_b32 v28, a183
    v_mul_f32 v28, v28, v29
    v_accvgpr_write_b32 a183, v28
    v_accvgpr_read_b32 v27, a184
    v_mul_f32 v27, v27, v29
    v_accvgpr_write_b32 a184, v27
    v_accvgpr_read_b32 v28, a185
    v_mul_f32 v28, v28, v29
    v_accvgpr_write_b32 a185, v28
    v_accvgpr_read_b32 v27, a186
    v_mul_f32 v27, v27, v29
    v_accvgpr_write_b32 a186, v27
    v_accvgpr_read_b32 v28, a187
    v_mul_f32 v28, v28, v29
    v_accvgpr_write_b32 a187, v28
    v_accvgpr_read_b32 v27, a188
    v_mul_f32 v27, v27, v29
    v_accvgpr_write_b32 a188, v27
    v_accvgpr_read_b32 v28, a189
    v_mul_f32 v28, v28, v29
    v_accvgpr_write_b32 a189, v28
    v_accvgpr_read_b32 v27, a190
    v_mul_f32 v27, v27, v29
    v_accvgpr_write_b32 a190, v27
    v_accvgpr_read_b32 v28, a191
    v_mul_f32 v28, v28, v29
    v_accvgpr_write_b32 a191, v28
    v_accvgpr_read_b32 v27, a208
    v_mul_f32 v27, v27, v29
    v_accvgpr_write_b32 a208, v27
    v_accvgpr_read_b32 v28, a209
    v_mul_f32 v28, v28, v29
    v_accvgpr_write_b32 a209, v28
    v_accvgpr_read_b32 v27, a210
    v_mul_f32 v27, v27, v29
    v_accvgpr_write_b32 a210, v27
    v_accvgpr_read_b32 v28, a211
    v_mul_f32 v28, v28, v29
    v_accvgpr_write_b32 a211, v28
    v_accvgpr_read_b32 v27, a212
    v_mul_f32 v27, v27, v29
    v_accvgpr_write_b32 a212, v27
    v_accvgpr_read_b32 v28, a213
    v_mul_f32 v28, v28, v29
    v_accvgpr_write_b32 a213, v28
    v_accvgpr_read_b32 v27, a214
    v_mul_f32 v27, v27, v29
    v_accvgpr_write_b32 a214, v27
    v_accvgpr_read_b32 v28, a215
    v_mul_f32 v28, v28, v29
    v_accvgpr_write_b32 a215, v28
    v_accvgpr_read_b32 v27, a216
    v_mul_f32 v27, v27, v29
    v_accvgpr_write_b32 a216, v27
    v_accvgpr_read_b32 v28, a217
    v_mul_f32 v28, v28, v29
    v_accvgpr_write_b32 a217, v28
    v_accvgpr_read_b32 v27, a218
    v_mul_f32 v27, v27, v29
    v_accvgpr_write_b32 a218, v27
    v_accvgpr_read_b32 v28, a219
    v_mul_f32 v28, v28, v29
    v_accvgpr_write_b32 a219, v28
    v_accvgpr_read_b32 v27, a220
    v_mul_f32 v27, v27, v29
    v_accvgpr_write_b32 a220, v27
    v_accvgpr_read_b32 v28, a221
    v_mul_f32 v28, v28, v29
    v_accvgpr_write_b32 a221, v28
    v_accvgpr_read_b32 v27, a222
    v_mul_f32 v27, v27, v29
    v_accvgpr_write_b32 a222, v27
    v_accvgpr_read_b32 v28, a223
    v_mul_f32 v28, v28, v29
    v_accvgpr_write_b32 a223, v28
    v_accvgpr_read_b32 v27, a240
    v_mul_f32 v27, v27, v29
    v_accvgpr_write_b32 a240, v27
    v_accvgpr_read_b32 v28, a241
    v_mul_f32 v28, v28, v29
    v_accvgpr_write_b32 a241, v28
    v_accvgpr_read_b32 v27, a242
    v_mul_f32 v27, v27, v29
    v_accvgpr_write_b32 a242, v27
    v_accvgpr_read_b32 v28, a243
    v_mul_f32 v28, v28, v29
    v_accvgpr_write_b32 a243, v28
    v_accvgpr_read_b32 v27, a244
    v_mul_f32 v27, v27, v29
    v_accvgpr_write_b32 a244, v27
    v_accvgpr_read_b32 v28, a245
    v_mul_f32 v28, v28, v29
    v_accvgpr_write_b32 a245, v28
    v_accvgpr_read_b32 v27, a246
    v_mul_f32 v27, v27, v29
    v_accvgpr_write_b32 a246, v27
    v_accvgpr_read_b32 v28, a247
    v_mul_f32 v28, v28, v29
    v_accvgpr_write_b32 a247, v28
    v_accvgpr_read_b32 v27, a248
    v_mul_f32 v27, v27, v29
    v_accvgpr_write_b32 a248, v27
    v_accvgpr_read_b32 v28, a249
    v_mul_f32 v28, v28, v29
    v_accvgpr_write_b32 a249, v28
    v_accvgpr_read_b32 v27, a250
    v_mul_f32 v27, v27, v29
    v_accvgpr_write_b32 a250, v27
    v_accvgpr_read_b32 v28, a251
    v_mul_f32 v28, v28, v29
    v_accvgpr_write_b32 a251, v28
    v_accvgpr_read_b32 v27, a252
    v_mul_f32 v27, v27, v29
    v_accvgpr_write_b32 a252, v27
    v_accvgpr_read_b32 v28, a253
    v_mul_f32 v28, v28, v29
    v_accvgpr_write_b32 a253, v28
    v_accvgpr_read_b32 v27, a254
    v_mul_f32 v27, v27, v29
    v_accvgpr_write_b32 a254, v27
    v_accvgpr_read_b32 v28, a255
    v_mul_f32 v28, v28, v29
    v_accvgpr_write_b32 a255, v28
    s_nop 1
    s_setpc_b64 s[40:41]
.section .rodata,"a"
.p2align 6
.amdhsa_kernel standalone__gqa_softmax__near_ridge_kernel
  .amdhsa_next_free_vgpr 512
  .amdhsa_next_free_sgpr 102
  .amdhsa_accum_offset 256
  .amdhsa_group_segment_fixed_size 0
  .amdhsa_kernarg_size 48
  .amdhsa_user_sgpr_count 2
  .amdhsa_user_sgpr_kernarg_segment_ptr 1
  .amdhsa_system_sgpr_workgroup_id_x 1
.end_amdhsa_kernel
```
